```python
import torch

def _softmax(x, axis=-1):
    return torch.softmax(x, dim=axis)
def _gelu(x):
    return torch.nn.functional.gelu(x, approximate="tanh")
def _silu(x):
    return torch.nn.functional.silu(x)
def _sigmoid(x):
    return torch.sigmoid(x)
def _layernorm(x, axis=-1, eps=1e-5):
    m = x.mean(dim=axis, keepdim=True)
    v = x.var(dim=axis, keepdim=True, unbiased=False)
    return (x - m) / torch.sqrt(v + eps)
def _scatter_add(tgt, idx, src, axis=0):
    return tgt.clone().index_add_(axis, idx, src)
def _segment_sum(src, seg, n):
    out = torch.zeros((n,) + src.shape[1:], dtype=src.dtype)
    return out.index_add_(0, seg, src)
def _pad(x, pw):
    flat = tuple(v for pair in reversed(pw) for v in pair)
    return torch.nn.functional.pad(x, flat)

kernel_name = 'recurrent_scan__grouped_kv_mqa__dense_activation_relu__prompt'

def setup_inputs():

    _w = (lambda a: (lambda t: t.to(torch.bfloat16) if t.is_floating_point() else t)(torch.as_tensor(a)))
    def _A_setup():
        B, S, D, H = 1, 2048, 512, 32
        Dh = D // H
        return {
            "x": _w((lambda *s: torch.randn(*s, dtype=torch.bfloat16) * 0.05)(B, S, D)),
            "wq": _w((lambda *s: torch.randn(*s, dtype=torch.bfloat16) * 0.05)(D, H * Dh)),
            "wk": _w((lambda *s: torch.randn(*s, dtype=torch.bfloat16) * 0.05)(D, Dh)),
            "wv": _w((lambda *s: torch.randn(*s, dtype=torch.bfloat16) * 0.05)(D, Dh)),
            "wo": _w((lambda *s: torch.randn(*s, dtype=torch.bfloat16) * 0.05)(H * Dh, D)),
        }
    _A_in = _A_setup()

    def _B_setup():
        B, S, D, Dff = 1, 2048, 512, 1792
        return {
            "x": _w((lambda *s: torch.randn(*s, dtype=torch.bfloat16) * 0.05)(B, S, D)),
            "w1": _w((lambda *s: torch.randn(*s, dtype=torch.bfloat16) * 0.05)(D, Dff)),
            "w2": _w((lambda *s: torch.randn(*s, dtype=torch.bfloat16) * 0.05)(Dff, D)),
        }
    _B_in = _B_setup()

    return {
        "A_x": _A_in["x"],
        "A_wq": _A_in["wq"],
        "A_wk": _A_in["wk"],
        "A_wv": _A_in["wv"],
        "A_wo": _A_in["wo"],
        "B_x": _B_in["x"],
        "B_w1": _B_in["w1"],
        "B_w2": _B_in["w2"],
    }

def reference(A_x, A_wq, A_wk, A_wv, A_wo, B_x, B_w1, B_w2):
    def _A_ref(x, wq, wk, wv, wo):
        B, S, D = x.shape
        H = 32
        Dh = D // H
        q = (lambda x, *d: x.permute(*d))((x @ wq).reshape(B, S, H, Dh), 0, 2, 1, 3)
        k = x @ wk
        v = x @ wv
        scores = torch.einsum("bhqd,bkd->bhqk", q, k) * (Dh ** -0.5)
        p = _softmax(scores, axis=-1)
        o = torch.einsum("bhqk,bkd->bhqd", p, v)
        return (lambda x, *d: x.permute(*d))(o, 0, 2, 1, 3).reshape(B, S, H * Dh) @ wo

    def _B_ref(x, w1, w2):
        h = torch.einsum("bsd,df->bsf", x, w1)
        zero = torch.zeros_like(h)
        h = torch.maximum(h, zero)
        return torch.einsum("bsf,fd->bsd", h, w2)

    x = A_x
    xn = _layernorm(x, axis=-1)
    s = _A_ref(xn, A_wq, A_wk, A_wv, A_wo)
    g = _silu(_B_ref(xn, B_w1, B_w2))
    return x + s * g
```

```asm
; @launch grid=(256,1,1) block=(768,1,1) lds=163344
.amdgcn_target "amdgcn-amd-amdhsa--gfx950"
.text
.globl recurrent_scan__grouped_kv_mqa__dense_activation_relu__prompt_kernel
.p2align 8
.type recurrent_scan__grouped_kv_mqa__dense_activation_relu__prompt_kernel,@function
recurrent_scan__grouped_kv_mqa__dense_activation_relu__prompt_kernel:
    s_load_dwordx16 s[4:19], s[0:1], 0
    s_load_dwordx8 s[20:27], s[0:1], 56
    v_lshrrev_b32 v3, 6, v0
    s_cmpk_ge_u32 s2, 256
    v_readfirstlane_b32 s48, v3
    s_cbranch_scc1 L_end
    s_and_b32 s52, s2, 7
    s_lshl_b32 s52, s52, 8
    s_and_b32 s53, s2, 0xf0
    v_and_b32 v1, 63, v0
    s_cmp_lt_u32 s48, 8
    v_lshlrev_b32 v2, 4, v1
    s_cbranch_scc1 L_a0
    s_setprio 3
    s_sub_u32 s56, s48, 8
    s_add_u32 s52, s52, s53
    s_lshl_b32 s52, s52, 10
    s_lshl_b32 s54, s56, 12
    s_add_u32 s52, s52, s54
    v_add_u32 v4, s52, v2
    v_add_u32 v5, s54, v2
    s_add_u32 m0, s54, 133120
    s_bitcmp1_b32 s2, 3
    s_waitcnt lgkmcnt(0)
    global_load_dwordx4 v[96:99], v4, s[4:5] offset:0
    global_load_dwordx4 v[100:103], v4, s[4:5] offset:1024
    global_load_dwordx4 v[104:107], v4, s[4:5] offset:2048
    global_load_dwordx4 v[108:111], v4, s[4:5] offset:3072
    s_cselect_b64 s[8:9], s[10:11], s[8:9]
    global_load_lds_dwordx4 v5, s[8:9] offset:0
    global_load_lds_dwordx4 v5, s[8:9] offset:1024
    global_load_lds_dwordx4 v5, s[8:9] offset:2048
    global_load_lds_dwordx4 v5, s[8:9] offset:3072
    v_mov_b32 v4, 135168
    global_load_dwordx2 v[28:29], v4, s[26:27]
    s_barrier
    s_branch L_ffn
L_a0:
    s_cmp_lg_u32 s48, 0
    s_cbranch_scc1 L_nopf
    s_getpc_b64 s[44:45]
    s_lshr_b32 s51, s2, 3
    s_lshl_b32 s51, s51, 10
    v_lshl_add_u32 v4, v0, 7, s51
    v_min_u32 v4, 0x7ac8, v4
    s_mov_b64 exec, 0xff
    global_load_dword v5, v4, s[44:45]
    s_mov_b64 exec, -1
    v_lshlrev_b32 v3, 2, v1
    v_add_u32 v3, 161792, v3
    v_mov_b32 v4, 0
    ds_write_b32 v3, v4
L_nopf:
    s_and_b32 s54, s2, 0xc0
    s_add_u32 s52, s52, s54
    s_mul_i32 s54, s48, 6
    s_add_u32 s53, s53, s54
    s_add_u32 s53, s53, 16
    s_add_u32 s54, s53, 0
    s_and_b32 s54, s54, 63
    s_add_u32 s54, s54, s52
    s_lshl_b32 s54, s54, 10
    v_add_u32 v12, s54, v2
    s_add_u32 s54, s53, 2
    s_and_b32 s54, s54, 63
    s_add_u32 s54, s54, s52
    s_lshl_b32 s54, s54, 10
    v_add_u32 v13, s54, v2
    s_add_u32 s54, s53, 4
    s_and_b32 s54, s54, 63
    s_add_u32 s54, s54, s52
    s_lshl_b32 s54, s54, 10
    v_add_u32 v14, s54, v2
    s_waitcnt lgkmcnt(0)
    s_barrier
    global_load_dwordx4 v[112:115], v12, s[4:5] offset:0
    global_load_dwordx4 v[116:119], v12, s[4:5] offset:1024
    global_load_dwordx4 v[120:123], v13, s[4:5] offset:0
    global_load_dwordx4 v[124:127], v13, s[4:5] offset:1024
    global_load_dwordx4 v[128:131], v14, s[4:5] offset:0
    global_load_dwordx4 v[132:135], v14, s[4:5] offset:1024
    s_branch L_attn
L_ffn:
    s_lshl_b32 s54, s56, 2
    s_add_u32 s53, s53, s54
    s_add_u32 s84, s53, 0
    s_and_b32 s84, s84, 63
    s_lshr_b32 s51, s84, 5
    s_mul_i32 s51, s51, 33280
    s_lshl_b32 s84, s84, 4
    s_add_u32 s84, s84, s51
    s_add_u32 s85, s53, 1
    s_and_b32 s85, s85, 63
    s_lshr_b32 s51, s85, 5
    s_mul_i32 s51, s51, 33280
    s_lshl_b32 s85, s85, 4
    s_add_u32 s85, s85, s51
    s_add_u32 s86, s53, 2
    s_and_b32 s86, s86, 63
    s_lshr_b32 s51, s86, 5
    s_mul_i32 s51, s51, 33280
    s_lshl_b32 s86, s86, 4
    s_add_u32 s86, s86, s51
    s_add_u32 s87, s53, 3
    s_and_b32 s87, s87, 63
    s_lshr_b32 s51, s87, 5
    s_mul_i32 s51, s51, 33280
    s_lshl_b32 s87, s87, 4
    s_add_u32 s87, s87, s51
    v_mul_u32_u24 v122, 528, v1
    v_mov_b32 v124, 0x00003f80
    v_mov_b32 v125, 0x3f800000
    v_lshrrev_b32 v126, 4, v1
    v_add_u32 v126, s53, v126
    v_and_b32 v126, 63, v126
    v_lshlrev_b32 v126, 2, v126
    v_lshrrev_b32 v3, 2, v1
    v_and_b32 v3, 4, v3
    v_and_b32 v4, 7, v1
    v_xor_b32 v4, v4, v3
    v_lshlrev_b32 v4, 4, v4
    v_lshrrev_b32 v3, 3, v1
    v_lshl_add_u32 v7, v3, 10, v4
    v_add_u32 v8, 7168, v7
    s_and_b32 s49, s2, 7
    s_lshl_b32 s49, s49, 2
    s_lshr_b32 s50, s2, 6
    s_add_u32 s49, s49, s50
    s_lshr_b32 s50, s2, 3
    s_and_b32 s50, s50, 7
    v_mov_b32 v6, 161792
    s_mov_b32 s57, 0x3f803f80
    s_mov_b64 s[28:29], s[4:5]
    s_mov_b32 s30, 0x200000
    s_mov_b32 s31, 0x20000
    s_mov_b64 s[32:33], s[26:27]
    s_mov_b32 s34, 0x2000000
    s_mov_b32 s35, 0x20000
    s_mov_b64 s[40:41], s[22:23]
    s_mov_b32 s42, 0x200000
    s_mov_b32 s43, 0x20000
    s_lshr_b32 s89, s50, 1
    v_mul_u32_u24 v9, 3584, v3
    v_add_u32 v9, v9, v4
    v_add_u32 v10, 27648, v9
    s_mul_i32 s90, s56, 12288
    s_add_u32 s90, s90, 67584
    v_and_b32 v3, 12, v1
    v_lshlrev_b32 v11, 5, v3
    v_lshrrev_b32 v3, 3, v1
    v_and_b32 v3, 2, v3
    v_bfe_u32 v4, v1, 1, 1
    v_or_b32 v3, v3, v4
    v_lshrrev_b32 v4, 1, v1
    v_and_b32 v4, 4, v4
    v_xor_b32 v3, v3, v4
    v_lshl_add_u32 v11, v3, 4, v11
    v_and_b32 v3, 1, v1
    v_lshl_add_u32 v11, v3, 3, v11
    v_lshrrev_b32 v15, 5, v1
    v_lshrrev_b32 v26, 4, v1
    v_and_b32 v27, 15, v1
    v_lshlrev_b32 v24, 3, v27
    v_lshl_add_u32 v24, v26, 8, v24
    v_add_u32 v24, 133120, v24
    v_mul_u32_u24 v25, 528, v26
    v_lshl_add_u32 v25, v27, 4, v25
    v_add_u32 v25, s84, v25
    s_lshr_b32 s92, s89, 1
    s_lshl_b32 s52, s49, 1
    s_add_u32 s92, s92, s52
    s_and_b32 s93, s89, 1
    s_and_b32 s54, s50, 1
    v_and_b32 v3, 1, v26
    v_lshlrev_b32 v3, 9, v3
    v_lshrrev_b32 v4, 1, v26
    v_lshl_add_u32 v3, v4, 3, v3
    v_lshl_add_u32 v23, v27, 4, v3
    s_lshl_b32 s91, s93, 8
    s_lshl_b32 s51, s92, 10
    s_add_u32 s91, s91, s51
    s_lshl_b32 s51, s54, 16
    s_add_u32 s91, s91, s51
    s_lshl_b32 s51, s89, 6
    s_add_u32 s51, s51, 163072
    v_lshlrev_b32 v3, 2, v27
    v_lshlrev_b32 v4, 4, v26
    s_cmp_eq_u32 s54, 0
    s_cselect_b64 vcc, -1, 0
    v_cndmask_b32 v22, v4, v3, vcc
    v_add_u32 v22, s51, v22
    s_waitcnt vmcnt(7)
    v_dot2_f32_bf16 v112, v96, s57, 0
    v_dot2_f32_bf16 v116, v96, v96, 0
    v_dot2_f32_bf16 v113, v100, s57, 0
    v_dot2_f32_bf16 v117, v100, v100, 0
    v_dot2_f32_bf16 v112, v97, s57, v112
    v_dot2_f32_bf16 v116, v97, v97, v116
    v_dot2_f32_bf16 v113, v101, s57, v113
    v_dot2_f32_bf16 v117, v101, v101, v117
    v_dot2_f32_bf16 v112, v98, s57, v112
    v_dot2_f32_bf16 v116, v98, v98, v116
    v_dot2_f32_bf16 v113, v102, s57, v113
    v_dot2_f32_bf16 v117, v102, v102, v117
    v_dot2_f32_bf16 v112, v99, s57, v112
    v_dot2_f32_bf16 v116, v99, v99, v116
    v_dot2_f32_bf16 v113, v103, s57, v113
    v_dot2_f32_bf16 v117, v103, v103, v117
    s_waitcnt vmcnt(5)
    v_dot2_f32_bf16 v114, v104, s57, 0
    v_dot2_f32_bf16 v118, v104, v104, 0
    v_dot2_f32_bf16 v115, v108, s57, 0
    v_dot2_f32_bf16 v119, v108, v108, 0
    v_dot2_f32_bf16 v114, v105, s57, v114
    v_dot2_f32_bf16 v118, v105, v105, v118
    v_dot2_f32_bf16 v115, v109, s57, v115
    v_dot2_f32_bf16 v119, v109, v109, v119
    v_dot2_f32_bf16 v114, v106, s57, v114
    v_dot2_f32_bf16 v118, v106, v106, v118
    v_dot2_f32_bf16 v115, v110, s57, v115
    v_dot2_f32_bf16 v119, v110, v110, v119
    v_dot2_f32_bf16 v114, v107, s57, v114
    v_dot2_f32_bf16 v118, v107, v107, v118
    v_dot2_f32_bf16 v115, v111, s57, v115
    v_dot2_f32_bf16 v119, v111, v111, v119
    s_nop 2
    v_permlane32_swap_b32 v112, v114
    v_permlane32_swap_b32 v113, v115
    v_permlane32_swap_b32 v116, v118
    v_permlane32_swap_b32 v117, v119
    v_add_f32 v112, v112, v114
    v_add_f32 v113, v113, v115
    v_add_f32 v116, v116, v118
    v_add_f32 v117, v117, v119
    s_nop 1
    v_permlane16_swap_b32 v112, v113
    v_permlane16_swap_b32 v116, v117
    s_nop 0
    v_add_f32 v112, v112, v113
    v_add_f32 v116, v116, v117
    s_nop 0
    v_add_f32_dpp v112, v112, v112 row_ror:8 row_mask:0xf bank_mask:0xf
    v_add_f32_dpp v116, v116, v116 row_ror:8 row_mask:0xf bank_mask:0xf
    s_nop 0
    v_add_f32_dpp v112, v112, v112 row_ror:4 row_mask:0xf bank_mask:0xf
    v_add_f32_dpp v116, v116, v116 row_ror:4 row_mask:0xf bank_mask:0xf
    s_nop 0
    v_add_f32_dpp v112, v112, v112 row_ror:2 row_mask:0xf bank_mask:0xf
    v_add_f32_dpp v116, v116, v116 row_ror:2 row_mask:0xf bank_mask:0xf
    s_nop 0
    v_add_f32_dpp v112, v112, v112 row_ror:1 row_mask:0xf bank_mask:0xf
    v_add_f32_dpp v116, v116, v116 row_ror:1 row_mask:0xf bank_mask:0xf
    v_mul_f32 v112, 0xbb000000, v112
    v_mul_f32 v116, 0x3b000000, v116
    v_cvt_pk_bf16_f32 v120, v112, v112
    v_fma_f32 v116, -v112, v112, v116
    v_lshlrev_b32 v120, 16, v120
    v_max_f32 v116, 0, v116
    v_readlane_b32 s60, v120, 0
    v_readlane_b32 s61, v120, 16
    v_readlane_b32 s62, v120, 32
    v_readlane_b32 s63, v120, 48
    v_cvt_pk_bf16_f32 v116, v116, v116
    v_dot2_f32_bf16 v136, v96, v124, s60
    v_dot2_f32_bf16 v137, v96, v125, s60
    v_dot2_f32_bf16 v138, v97, v124, s60
    v_lshlrev_b32 v116, 16, v116
    v_dot2_f32_bf16 v139, v97, v125, s60
    v_dot2_f32_bf16 v140, v98, v124, s60
    v_dot2_f32_bf16 v141, v98, v125, s60
    v_add_f32 v116, 0x3727c5ac, v116
    v_dot2_f32_bf16 v142, v99, v124, s60
    v_dot2_f32_bf16 v143, v99, v125, s60
    v_dot2_f32_bf16 v144, v100, v124, s61
    v_cvt_pk_bf16_f32 v116, v116, v116
    v_dot2_f32_bf16 v145, v100, v125, s61
    v_dot2_f32_bf16 v146, v101, v124, s61
    v_dot2_f32_bf16 v147, v101, v125, s61
    v_lshlrev_b32 v116, 16, v116
    v_dot2_f32_bf16 v148, v102, v124, s61
    v_dot2_f32_bf16 v149, v102, v125, s61
    v_dot2_f32_bf16 v150, v103, v124, s61
    v_sqrt_f32 v116, v116
    v_dot2_f32_bf16 v151, v103, v125, s61
    v_add_u32 v123, s84, v122
    v_cvt_pk_bf16_f32 v96, v136, v137
    v_cvt_pk_bf16_f32 v116, v116, v116
    v_cvt_pk_bf16_f32 v97, v138, v139
    v_cvt_pk_bf16_f32 v98, v140, v141
    v_cvt_pk_bf16_f32 v99, v142, v143
    v_lshlrev_b32 v116, 16, v116
    ds_write_b128 v123, v[96:99]
    v_dot2_f32_bf16 v136, v104, v124, s62
    v_dot2_f32_bf16 v137, v104, v125, s62
    v_rcp_f32 v116, v116
    v_dot2_f32_bf16 v138, v105, v124, s62
    v_dot2_f32_bf16 v139, v105, v125, s62
    v_dot2_f32_bf16 v140, v106, v124, s62
    v_add_u32 v126, 163072, v126
    v_dot2_f32_bf16 v141, v106, v125, s62
    v_dot2_f32_bf16 v142, v107, v124, s62
    v_dot2_f32_bf16 v143, v107, v125, s62
    ds_write_b32 v126, v116
    v_add_u32 v123, s85, v122
    v_cvt_pk_bf16_f32 v100, v144, v145
    v_cvt_pk_bf16_f32 v101, v146, v147
    v_cvt_pk_bf16_f32 v102, v148, v149
    v_cvt_pk_bf16_f32 v103, v150, v151
    ds_write_b128 v123, v[100:103]
    v_dot2_f32_bf16 v144, v108, v124, s63
    v_dot2_f32_bf16 v145, v108, v125, s63
    v_dot2_f32_bf16 v146, v109, v124, s63
    v_dot2_f32_bf16 v147, v109, v125, s63
    v_dot2_f32_bf16 v148, v110, v124, s63
    v_dot2_f32_bf16 v149, v110, v125, s63
    v_dot2_f32_bf16 v150, v111, v124, s63
    v_dot2_f32_bf16 v151, v111, v125, s63
    v_add_u32 v123, s86, v122
    v_cvt_pk_bf16_f32 v104, v136, v137
    v_cvt_pk_bf16_f32 v105, v138, v139
    v_cvt_pk_bf16_f32 v106, v140, v141
    v_cvt_pk_bf16_f32 v107, v142, v143
    ds_write_b128 v123, v[104:107]
    v_add_u32 v123, s87, v122
    v_cvt_pk_bf16_f32 v108, v144, v145
    v_cvt_pk_bf16_f32 v109, v146, v147
    v_cvt_pk_bf16_f32 v110, v148, v149
    v_cvt_pk_bf16_f32 v111, v150, v151
    ds_write_b128 v123, v[108:111]
    s_waitcnt vmcnt(1)
    s_waitcnt lgkmcnt(0)
    v_mov_b32 v3, 1
    s_mov_b64 exec, 1
    ds_add_u32 v6, v3 offset:0
    s_mov_b64 exec, -1
    s_cmp_lg_u32 s56, 0
    s_cbranch_scc1 L_nokv_1
    s_mov_b32 s3, 2097152
L_lw_2:
    ds_read_b32 v3, v6 offset:0
    s_sub_u32 s3, s3, 1
    s_waitcnt lgkmcnt(0)
    v_cmp_gt_u32 vcc, 4, v3
    s_cbranch_vccz L_lwd_3
    s_sleep 0
    s_cbranch_scc0 L_lw_2
L_lwd_3:
    ds_read2_b32 v[32:33], v22 offset0:0 offset1:1
    ds_read2_b32 v[34:35], v22 offset0:2 offset1:3
    ds_read_b64_tr_b16 v[96:97], v24 offset:0
    ds_read_b64_tr_b16 v[98:99], v24 offset:128
    ds_read_b128 v[100:103], v25 offset:0
    ds_read_b64_tr_b16 v[104:105], v24 offset:1024
    ds_read_b64_tr_b16 v[106:107], v24 offset:1152
    ds_read_b128 v[108:111], v25 offset:2112
    ds_read_b64_tr_b16 v[112:113], v24 offset:2048
    ds_read_b64_tr_b16 v[114:115], v24 offset:2176
    ds_read_b128 v[116:119], v25 offset:4224
    ds_read_b64_tr_b16 v[120:121], v24 offset:3072
    ds_read_b64_tr_b16 v[122:123], v24 offset:3200
    ds_read_b128 v[124:127], v25 offset:6336
    s_bitcmp1_b32 s50, 0
    s_cbranch_scc1 L_kvv_4
    s_waitcnt lgkmcnt(9)
    v_mfma_f32_16x16x32_bf16 v[16:19], v[96:99], v[100:103], 0
    ds_read_b64_tr_b16 v[96:97], v24 offset:4096
    ds_read_b64_tr_b16 v[98:99], v24 offset:4224
    ds_read_b128 v[100:103], v25 offset:8448
    s_waitcnt lgkmcnt(9)
    v_mfma_f32_16x16x32_bf16 v[16:19], v[104:107], v[108:111], v[16:19]
    ds_read_b64_tr_b16 v[104:105], v24 offset:5120
    ds_read_b64_tr_b16 v[106:107], v24 offset:5248
    ds_read_b128 v[108:111], v25 offset:10560
    s_waitcnt lgkmcnt(9)
    v_mfma_f32_16x16x32_bf16 v[16:19], v[112:115], v[116:119], v[16:19]
    ds_read_b64_tr_b16 v[112:113], v24 offset:6144
    ds_read_b64_tr_b16 v[114:115], v24 offset:6272
    ds_read_b128 v[116:119], v25 offset:12672
    s_waitcnt lgkmcnt(9)
    v_mfma_f32_16x16x32_bf16 v[16:19], v[120:123], v[124:127], v[16:19]
    ds_read_b64_tr_b16 v[120:121], v24 offset:7168
    ds_read_b64_tr_b16 v[122:123], v24 offset:7296
    ds_read_b128 v[124:127], v25 offset:14784
    s_waitcnt lgkmcnt(9)
    v_mfma_f32_16x16x32_bf16 v[16:19], v[96:99], v[100:103], v[16:19]
    ds_read_b64_tr_b16 v[96:97], v24 offset:8192
    ds_read_b64_tr_b16 v[98:99], v24 offset:8320
    ds_read_b128 v[100:103], v25 offset:16896
    s_waitcnt lgkmcnt(9)
    v_mfma_f32_16x16x32_bf16 v[16:19], v[104:107], v[108:111], v[16:19]
    ds_read_b64_tr_b16 v[104:105], v24 offset:9216
    ds_read_b64_tr_b16 v[106:107], v24 offset:9344
    ds_read_b128 v[108:111], v25 offset:19008
    s_waitcnt lgkmcnt(9)
    v_mfma_f32_16x16x32_bf16 v[16:19], v[112:115], v[116:119], v[16:19]
    ds_read_b64_tr_b16 v[112:113], v24 offset:10240
    ds_read_b64_tr_b16 v[114:115], v24 offset:10368
    ds_read_b128 v[116:119], v25 offset:21120
    s_waitcnt lgkmcnt(9)
    v_mfma_f32_16x16x32_bf16 v[16:19], v[120:123], v[124:127], v[16:19]
    ds_read_b64_tr_b16 v[120:121], v24 offset:11264
    ds_read_b64_tr_b16 v[122:123], v24 offset:11392
    ds_read_b128 v[124:127], v25 offset:23232
    s_waitcnt lgkmcnt(9)
    v_mfma_f32_16x16x32_bf16 v[16:19], v[96:99], v[100:103], v[16:19]
    ds_read_b64_tr_b16 v[96:97], v24 offset:12288
    ds_read_b64_tr_b16 v[98:99], v24 offset:12416
    ds_read_b128 v[100:103], v25 offset:25344
    s_waitcnt lgkmcnt(9)
    v_mfma_f32_16x16x32_bf16 v[16:19], v[104:107], v[108:111], v[16:19]
    ds_read_b64_tr_b16 v[104:105], v24 offset:13312
    ds_read_b64_tr_b16 v[106:107], v24 offset:13440
    ds_read_b128 v[108:111], v25 offset:27456
    s_waitcnt lgkmcnt(9)
    v_mfma_f32_16x16x32_bf16 v[16:19], v[112:115], v[116:119], v[16:19]
    ds_read_b64_tr_b16 v[112:113], v24 offset:14336
    ds_read_b64_tr_b16 v[114:115], v24 offset:14464
    ds_read_b128 v[116:119], v25 offset:29568
    s_waitcnt lgkmcnt(9)
    v_mfma_f32_16x16x32_bf16 v[16:19], v[120:123], v[124:127], v[16:19]
    ds_read_b64_tr_b16 v[120:121], v24 offset:15360
    ds_read_b64_tr_b16 v[122:123], v24 offset:15488
    ds_read_b128 v[124:127], v25 offset:31680
    s_waitcnt lgkmcnt(9)
    v_mfma_f32_16x16x32_bf16 v[16:19], v[96:99], v[100:103], v[16:19]
    s_waitcnt lgkmcnt(6)
    v_mfma_f32_16x16x32_bf16 v[16:19], v[104:107], v[108:111], v[16:19]
    s_waitcnt lgkmcnt(3)
    v_mfma_f32_16x16x32_bf16 v[16:19], v[112:115], v[116:119], v[16:19]
    s_waitcnt lgkmcnt(0)
    v_mfma_f32_16x16x32_bf16 v[16:19], v[120:123], v[124:127], v[16:19]
    s_nop 7
    v_pk_mul_f32 v[16:17], v[16:17], v[32:33] op_sel_hi:[1,0]
    v_pk_mul_f32 v[18:19], v[18:19], v[32:33] op_sel_hi:[1,0]
    s_branch L_kvs_5
L_kvv_4:
    s_waitcnt lgkmcnt(9)
    v_mfma_f32_16x16x32_bf16 v[16:19], v[100:103], v[96:99], 0
    ds_read_b64_tr_b16 v[96:97], v24 offset:4096
    ds_read_b64_tr_b16 v[98:99], v24 offset:4224
    ds_read_b128 v[100:103], v25 offset:8448
    s_waitcnt lgkmcnt(9)
    v_mfma_f32_16x16x32_bf16 v[16:19], v[108:111], v[104:107], v[16:19]
    ds_read_b64_tr_b16 v[104:105], v24 offset:5120
    ds_read_b64_tr_b16 v[106:107], v24 offset:5248
    ds_read_b128 v[108:111], v25 offset:10560
    s_waitcnt lgkmcnt(9)
    v_mfma_f32_16x16x32_bf16 v[16:19], v[116:119], v[112:115], v[16:19]
    ds_read_b64_tr_b16 v[112:113], v24 offset:6144
    ds_read_b64_tr_b16 v[114:115], v24 offset:6272
    ds_read_b128 v[116:119], v25 offset:12672
    s_waitcnt lgkmcnt(9)
    v_mfma_f32_16x16x32_bf16 v[16:19], v[124:127], v[120:123], v[16:19]
    ds_read_b64_tr_b16 v[120:121], v24 offset:7168
    ds_read_b64_tr_b16 v[122:123], v24 offset:7296
    ds_read_b128 v[124:127], v25 offset:14784
    s_waitcnt lgkmcnt(9)
    v_mfma_f32_16x16x32_bf16 v[16:19], v[100:103], v[96:99], v[16:19]
    ds_read_b64_tr_b16 v[96:97], v24 offset:8192
    ds_read_b64_tr_b16 v[98:99], v24 offset:8320
    ds_read_b128 v[100:103], v25 offset:16896
    s_waitcnt lgkmcnt(9)
    v_mfma_f32_16x16x32_bf16 v[16:19], v[108:111], v[104:107], v[16:19]
    ds_read_b64_tr_b16 v[104:105], v24 offset:9216
    ds_read_b64_tr_b16 v[106:107], v24 offset:9344
    ds_read_b128 v[108:111], v25 offset:19008
    s_waitcnt lgkmcnt(9)
    v_mfma_f32_16x16x32_bf16 v[16:19], v[116:119], v[112:115], v[16:19]
    ds_read_b64_tr_b16 v[112:113], v24 offset:10240
    ds_read_b64_tr_b16 v[114:115], v24 offset:10368
    ds_read_b128 v[116:119], v25 offset:21120
    s_waitcnt lgkmcnt(9)
    v_mfma_f32_16x16x32_bf16 v[16:19], v[124:127], v[120:123], v[16:19]
    ds_read_b64_tr_b16 v[120:121], v24 offset:11264
    ds_read_b64_tr_b16 v[122:123], v24 offset:11392
    ds_read_b128 v[124:127], v25 offset:23232
    s_waitcnt lgkmcnt(9)
    v_mfma_f32_16x16x32_bf16 v[16:19], v[100:103], v[96:99], v[16:19]
    ds_read_b64_tr_b16 v[96:97], v24 offset:12288
    ds_read_b64_tr_b16 v[98:99], v24 offset:12416
    ds_read_b128 v[100:103], v25 offset:25344
    s_waitcnt lgkmcnt(9)
    v_mfma_f32_16x16x32_bf16 v[16:19], v[108:111], v[104:107], v[16:19]
    ds_read_b64_tr_b16 v[104:105], v24 offset:13312
    ds_read_b64_tr_b16 v[106:107], v24 offset:13440
    ds_read_b128 v[108:111], v25 offset:27456
    s_waitcnt lgkmcnt(9)
    v_mfma_f32_16x16x32_bf16 v[16:19], v[116:119], v[112:115], v[16:19]
    ds_read_b64_tr_b16 v[112:113], v24 offset:14336
    ds_read_b64_tr_b16 v[114:115], v24 offset:14464
    ds_read_b128 v[116:119], v25 offset:29568
    s_waitcnt lgkmcnt(9)
    v_mfma_f32_16x16x32_bf16 v[16:19], v[124:127], v[120:123], v[16:19]
    ds_read_b64_tr_b16 v[120:121], v24 offset:15360
    ds_read_b64_tr_b16 v[122:123], v24 offset:15488
    ds_read_b128 v[124:127], v25 offset:31680
    s_waitcnt lgkmcnt(9)
    v_mfma_f32_16x16x32_bf16 v[16:19], v[100:103], v[96:99], v[16:19]
    s_waitcnt lgkmcnt(6)
    v_mfma_f32_16x16x32_bf16 v[16:19], v[108:111], v[104:107], v[16:19]
    s_waitcnt lgkmcnt(3)
    v_mfma_f32_16x16x32_bf16 v[16:19], v[116:119], v[112:115], v[16:19]
    s_waitcnt lgkmcnt(0)
    v_mfma_f32_16x16x32_bf16 v[16:19], v[124:127], v[120:123], v[16:19]
    s_nop 7
    v_pk_mul_f32 v[16:17], v[16:17], v[32:33]
    v_pk_mul_f32 v[18:19], v[18:19], v[34:35]
L_kvs_5:
    v_cvt_pk_bf16_f32 v16, v16, v17
    v_cvt_pk_bf16_f32 v17, v18, v19
    buffer_store_dwordx2 v[16:17], v23, s[32:35], s91 offen sc1
    v_dot2_f32_bf16 v30, v16, v16, 0
    v_dot2_f32_bf16 v30, v17, v17, v30
    s_lshl_b32 s51, s92, 2
    s_lshl_b32 s52, s93, 1
    s_add_u32 s51, s51, s52
    s_add_u32 s51, s51, s54
    s_lshl_b32 s51, s51, 7
    s_add_u32 s51, s51, 163840
    v_mov_b32 v19, v30
    s_nop 1
    v_permlane16_swap_b32 v30, v19
    s_nop 0
    v_add_f32 v30, v30, v19
    v_mov_b32 v19, v30
    s_nop 1
    v_permlane32_swap_b32 v30, v19
    s_nop 0
    v_add_f32 v30, v30, v19
    s_nop 1
    v_max_f32_dpp v30, v30, v30 row_ror:8 row_mask:0xf bank_mask:0xf
    s_nop 1
    v_max_f32_dpp v30, v30, v30 row_ror:4 row_mask:0xf bank_mask:0xf
    s_nop 1
    v_max_f32_dpp v30, v30, v30 row_ror:2 row_mask:0xf bank_mask:0xf
    s_nop 1
    v_max_f32_dpp v30, v30, v30 row_ror:1 row_mask:0xf bank_mask:0xf
    s_sub_u32 s52, s54, 1
    v_and_b32 v30, s52, v30
    v_mov_b32 v4, 0
    s_waitcnt vmcnt(1)
    v_add_co_u32 v28, vcc, 1, v28
    s_nop 1
    v_addc_co_u32 v29, vcc, 0, v29, vcc
    v_mov_b32 v31, v28
    s_mov_b64 exec, 1
    s_waitcnt vmcnt(0)
    buffer_store_dwordx4 v[28:31], v4, s[32:35], s51 offen sc1
    s_mov_b64 exec, -1
    ds_write_b64 v6, v[28:29] offset:64
    s_waitcnt lgkmcnt(0)
    v_mov_b32 v3, 1
    s_mov_b64 exec, 1
    ds_add_u32 v6, v3 offset:80
    s_mov_b64 exec, -1
    s_branch L_kvj_6
L_nokv_1:
L_kvj_6:
    s_and_b32 s51, s56, 1
    s_mul_i32 s51, s51, 33792
    v_and_b32 v14, 31, v1
    v_lshlrev_b32 v14, 4, v14
    v_mul_u32_u24 v3, 528, v15
    v_add_u32 v14, v14, v3
    v_add_u32 v5, s51, v14
    s_lshr_b32 s52, s56, 1
    s_lshl_b32 s52, s52, 6
    v_lshl_add_u32 v12, v15, 10, v11
    v_xor_b32 v12, s52, v12
    v_add_u32 v12, 67584, v12
    s_mov_b32 s3, 2097152
L_lw_7:
    ds_read_b32 v3, v6 offset:80
    s_sub_u32 s3, s3, 1
    s_waitcnt lgkmcnt(0)
    v_cmp_gt_u32 vcc, 1, v3
    s_cbranch_vccz L_lwd_8
    s_sleep 1
    s_cbranch_scc0 L_lw_7
L_lwd_8:
    s_mov_b32 s36, s6
    s_mov_b32 s37, s7
    s_mov_b32 s38, 0x80000
    s_mov_b32 s39, 0x20000
    s_mul_i32 s52, s56, 131072
    s_lshl_b32 s51, s50, 7
    s_add_u32 s52, s52, s51
    s_mul_i32 s51, s56, 16384
    s_add_u32 m0, s51, 67584
    s_nop 0
    buffer_load_dwordx4 v7, s[36:39], s52 offen lds
    buffer_load_dwordx4 v8, s[36:39], s52 offen offset:1024 lds
    s_add_u32 m0, s51, 69632
    s_add_u32 s52, s52, 16384
    buffer_load_dwordx4 v7, s[36:39], s52 offen lds
    buffer_load_dwordx4 v8, s[36:39], s52 offen offset:1024 lds
    s_add_u32 m0, s51, 71680
    s_add_u32 s52, s52, 16384
    buffer_load_dwordx4 v7, s[36:39], s52 offen lds
    buffer_load_dwordx4 v8, s[36:39], s52 offen offset:1024 lds
    s_add_u32 m0, s51, 73728
    s_add_u32 s52, s52, 16384
    buffer_load_dwordx4 v7, s[36:39], s52 offen lds
    buffer_load_dwordx4 v8, s[36:39], s52 offen offset:1024 lds
    s_add_u32 m0, s51, 75776
    s_add_u32 s52, s52, 16384
    buffer_load_dwordx4 v7, s[36:39], s52 offen lds
    buffer_load_dwordx4 v8, s[36:39], s52 offen offset:1024 lds
    s_add_u32 m0, s51, 77824
    s_add_u32 s52, s52, 16384
    buffer_load_dwordx4 v7, s[36:39], s52 offen lds
    buffer_load_dwordx4 v8, s[36:39], s52 offen offset:1024 lds
    s_add_u32 m0, s51, 79872
    s_add_u32 s52, s52, 16384
    buffer_load_dwordx4 v7, s[36:39], s52 offen lds
    buffer_load_dwordx4 v8, s[36:39], s52 offen offset:1024 lds
    s_add_u32 m0, s51, 81920
    s_add_u32 s52, s52, 16384
    buffer_load_dwordx4 v7, s[36:39], s52 offen lds
    buffer_load_dwordx4 v8, s[36:39], s52 offen offset:1024 lds
    s_waitcnt vmcnt(0)
    s_waitcnt lgkmcnt(0)
    v_mov_b32 v3, 1
    s_mov_b64 exec, 1
    ds_add_u32 v6, v3 offset:84
    s_mov_b64 exec, -1
    s_mov_b32 s3, 2097152
L_lw_9:
    ds_read_b32 v3, v6 offset:84
    s_sub_u32 s3, s3, 1
    s_waitcnt lgkmcnt(0)
    v_cmp_gt_u32 vcc, 4, v3
    s_cbranch_vccz L_lwd_10
    s_sleep 1
    s_cbranch_scc0 L_lw_9
L_lwd_10:
    s_mov_b32 s3, 2097152
L_lw_11:
    ds_read_b32 v3, v6 offset:100
    s_sub_u32 s3, s3, 1
    s_waitcnt lgkmcnt(0)
    v_cmp_gt_u32 vcc, 8, v3
    s_cbranch_vccz L_lwd_12
    s_sleep 1
    s_cbranch_scc0 L_lw_11
L_lwd_12:
    s_and_b32 s51, s56, 1
    s_lshl_b32 s51, s51, 7
    s_add_u32 s51, s51, 163072
    v_and_b32 v80, 31, v1
    v_lshl_add_u32 v80, v80, 2, s51
    ds_read_b32 v80, v80
    ds_read_b64_tr_b16 v[96:97], v12 offset:0
    ds_read_b64_tr_b16 v[98:99], v12 offset:512
    ds_read_b128 v[100:103], v5 offset:0
    ds_read_b64_tr_b16 v[104:105], v12 offset:2048
    ds_read_b64_tr_b16 v[106:107], v12 offset:2560
    ds_read_b128 v[108:111], v5 offset:1056
    ds_read_b64_tr_b16 v[112:113], v12 offset:4096
    ds_read_b64_tr_b16 v[114:115], v12 offset:4608
    ds_read_b128 v[116:119], v5 offset:2112
    ds_read_b64_tr_b16 v[120:121], v12 offset:6144
    ds_read_b64_tr_b16 v[122:123], v12 offset:6656
    ds_read_b128 v[124:127], v5 offset:3168
    ds_read_b64_tr_b16 v[128:129], v12 offset:8192
    ds_read_b64_tr_b16 v[130:131], v12 offset:8704
    ds_read_b128 v[132:135], v5 offset:4224
    s_waitcnt lgkmcnt(12)
    v_mfma_f32_32x32x16_bf16 v[16:31], v[96:99], v[100:103], 0
    ds_read_b64_tr_b16 v[96:97], v12 offset:10240
    ds_read_b64_tr_b16 v[98:99], v12 offset:10752
    ds_read_b128 v[100:103], v5 offset:5280
    s_waitcnt lgkmcnt(12)
    v_mfma_f32_32x32x16_bf16 v[16:31], v[104:107], v[108:111], v[16:31]
    ds_read_b64_tr_b16 v[104:105], v12 offset:12288
    ds_read_b64_tr_b16 v[106:107], v12 offset:12800
    ds_read_b128 v[108:111], v5 offset:6336
    s_waitcnt lgkmcnt(12)
    v_mfma_f32_32x32x16_bf16 v[16:31], v[112:115], v[116:119], v[16:31]
    ds_read_b64_tr_b16 v[112:113], v12 offset:14336
    ds_read_b64_tr_b16 v[114:115], v12 offset:14848
    ds_read_b128 v[116:119], v5 offset:7392
    s_waitcnt lgkmcnt(12)
    v_mfma_f32_32x32x16_bf16 v[16:31], v[120:123], v[124:127], v[16:31]
    ds_read_b64_tr_b16 v[120:121], v12 offset:16384
    ds_read_b64_tr_b16 v[122:123], v12 offset:16896
    ds_read_b128 v[124:127], v5 offset:8448
    s_waitcnt lgkmcnt(12)
    v_mfma_f32_32x32x16_bf16 v[16:31], v[128:131], v[132:135], v[16:31]
    ds_read_b64_tr_b16 v[128:129], v12 offset:18432
    ds_read_b64_tr_b16 v[130:131], v12 offset:18944
    ds_read_b128 v[132:135], v5 offset:9504
    s_waitcnt lgkmcnt(12)
    v_mfma_f32_32x32x16_bf16 v[16:31], v[96:99], v[100:103], v[16:31]
    ds_read_b64_tr_b16 v[96:97], v12 offset:20480
    ds_read_b64_tr_b16 v[98:99], v12 offset:20992
    ds_read_b128 v[100:103], v5 offset:10560
    s_waitcnt lgkmcnt(12)
    v_mfma_f32_32x32x16_bf16 v[16:31], v[104:107], v[108:111], v[16:31]
    ds_read_b64_tr_b16 v[104:105], v12 offset:22528
    ds_read_b64_tr_b16 v[106:107], v12 offset:23040
    ds_read_b128 v[108:111], v5 offset:11616
    s_waitcnt lgkmcnt(12)
    v_mfma_f32_32x32x16_bf16 v[16:31], v[112:115], v[116:119], v[16:31]
    ds_read_b64_tr_b16 v[112:113], v12 offset:24576
    ds_read_b64_tr_b16 v[114:115], v12 offset:25088
    ds_read_b128 v[116:119], v5 offset:12672
    s_waitcnt lgkmcnt(12)
    v_mfma_f32_32x32x16_bf16 v[16:31], v[120:123], v[124:127], v[16:31]
    ds_read_b64_tr_b16 v[120:121], v12 offset:26624
    ds_read_b64_tr_b16 v[122:123], v12 offset:27136
    ds_read_b128 v[124:127], v5 offset:13728
    s_waitcnt lgkmcnt(12)
    v_mfma_f32_32x32x16_bf16 v[16:31], v[128:131], v[132:135], v[16:31]
    ds_read_b64_tr_b16 v[128:129], v12 offset:28672
    ds_read_b64_tr_b16 v[130:131], v12 offset:29184
    ds_read_b128 v[132:135], v5 offset:14784
    s_waitcnt lgkmcnt(12)
    v_mfma_f32_32x32x16_bf16 v[16:31], v[96:99], v[100:103], v[16:31]
    ds_read_b64_tr_b16 v[96:97], v12 offset:30720
    ds_read_b64_tr_b16 v[98:99], v12 offset:31232
    ds_read_b128 v[100:103], v5 offset:15840
    s_waitcnt lgkmcnt(12)
    v_mfma_f32_32x32x16_bf16 v[16:31], v[104:107], v[108:111], v[16:31]
    ds_read_b64_tr_b16 v[104:105], v12 offset:32768
    ds_read_b64_tr_b16 v[106:107], v12 offset:33280
    ds_read_b128 v[108:111], v5 offset:16896
    s_waitcnt lgkmcnt(12)
    v_mfma_f32_32x32x16_bf16 v[16:31], v[112:115], v[116:119], v[16:31]
    ds_read_b64_tr_b16 v[112:113], v12 offset:34816
    ds_read_b64_tr_b16 v[114:115], v12 offset:35328
    ds_read_b128 v[116:119], v5 offset:17952
    s_waitcnt lgkmcnt(12)
    v_mfma_f32_32x32x16_bf16 v[16:31], v[120:123], v[124:127], v[16:31]
    ds_read_b64_tr_b16 v[120:121], v12 offset:36864
    ds_read_b64_tr_b16 v[122:123], v12 offset:37376
    ds_read_b128 v[124:127], v5 offset:19008
    s_waitcnt lgkmcnt(12)
    v_mfma_f32_32x32x16_bf16 v[16:31], v[128:131], v[132:135], v[16:31]
    ds_read_b64_tr_b16 v[128:129], v12 offset:38912
    ds_read_b64_tr_b16 v[130:131], v12 offset:39424
    ds_read_b128 v[132:135], v5 offset:20064
    s_waitcnt lgkmcnt(12)
    v_mfma_f32_32x32x16_bf16 v[16:31], v[96:99], v[100:103], v[16:31]
    ds_read_b64_tr_b16 v[96:97], v12 offset:40960
    ds_read_b64_tr_b16 v[98:99], v12 offset:41472
    ds_read_b128 v[100:103], v5 offset:21120
    s_waitcnt lgkmcnt(12)
    v_mfma_f32_32x32x16_bf16 v[16:31], v[104:107], v[108:111], v[16:31]
    ds_read_b64_tr_b16 v[104:105], v12 offset:43008
    ds_read_b64_tr_b16 v[106:107], v12 offset:43520
    ds_read_b128 v[108:111], v5 offset:22176
    s_waitcnt lgkmcnt(12)
    v_mfma_f32_32x32x16_bf16 v[16:31], v[112:115], v[116:119], v[16:31]
    ds_read_b64_tr_b16 v[112:113], v12 offset:45056
    ds_read_b64_tr_b16 v[114:115], v12 offset:45568
    ds_read_b128 v[116:119], v5 offset:23232
    s_waitcnt lgkmcnt(12)
    v_mfma_f32_32x32x16_bf16 v[16:31], v[120:123], v[124:127], v[16:31]
    ds_read_b64_tr_b16 v[120:121], v12 offset:47104
    ds_read_b64_tr_b16 v[122:123], v12 offset:47616
    ds_read_b128 v[124:127], v5 offset:24288
    s_waitcnt lgkmcnt(12)
    v_mfma_f32_32x32x16_bf16 v[16:31], v[128:131], v[132:135], v[16:31]
    ds_read_b64_tr_b16 v[128:129], v12 offset:49152
    ds_read_b64_tr_b16 v[130:131], v12 offset:49664
    ds_read_b128 v[132:135], v5 offset:25344
    s_waitcnt lgkmcnt(12)
    v_mfma_f32_32x32x16_bf16 v[16:31], v[96:99], v[100:103], v[16:31]
    ds_read_b64_tr_b16 v[96:97], v12 offset:51200
    ds_read_b64_tr_b16 v[98:99], v12 offset:51712
    ds_read_b128 v[100:103], v5 offset:26400
    s_waitcnt lgkmcnt(12)
    v_mfma_f32_32x32x16_bf16 v[16:31], v[104:107], v[108:111], v[16:31]
    ds_read_b64_tr_b16 v[104:105], v12 offset:53248
    ds_read_b64_tr_b16 v[106:107], v12 offset:53760
    ds_read_b128 v[108:111], v5 offset:27456
    s_waitcnt lgkmcnt(12)
    v_mfma_f32_32x32x16_bf16 v[16:31], v[112:115], v[116:119], v[16:31]
    ds_read_b64_tr_b16 v[112:113], v12 offset:55296
    ds_read_b64_tr_b16 v[114:115], v12 offset:55808
    ds_read_b128 v[116:119], v5 offset:28512
    s_waitcnt lgkmcnt(12)
    v_mfma_f32_32x32x16_bf16 v[16:31], v[120:123], v[124:127], v[16:31]
    ds_read_b64_tr_b16 v[120:121], v12 offset:57344
    ds_read_b64_tr_b16 v[122:123], v12 offset:57856
    ds_read_b128 v[124:127], v5 offset:29568
    s_waitcnt lgkmcnt(12)
    v_mfma_f32_32x32x16_bf16 v[16:31], v[128:131], v[132:135], v[16:31]
    ds_read_b64_tr_b16 v[128:129], v12 offset:59392
    ds_read_b64_tr_b16 v[130:131], v12 offset:59904
    ds_read_b128 v[132:135], v5 offset:30624
    s_waitcnt lgkmcnt(12)
    v_mfma_f32_32x32x16_bf16 v[16:31], v[96:99], v[100:103], v[16:31]
    ds_read_b64_tr_b16 v[96:97], v12 offset:61440
    ds_read_b64_tr_b16 v[98:99], v12 offset:61952
    ds_read_b128 v[100:103], v5 offset:31680
    s_waitcnt lgkmcnt(12)
    v_mfma_f32_32x32x16_bf16 v[16:31], v[104:107], v[108:111], v[16:31]
    ds_read_b64_tr_b16 v[104:105], v12 offset:63488
    ds_read_b64_tr_b16 v[106:107], v12 offset:64000
    ds_read_b128 v[108:111], v5 offset:32736
    s_waitcnt lgkmcnt(12)
    v_mfma_f32_32x32x16_bf16 v[16:31], v[112:115], v[116:119], v[16:31]
    s_waitcnt lgkmcnt(9)
    v_mfma_f32_32x32x16_bf16 v[16:31], v[120:123], v[124:127], v[16:31]
    s_waitcnt lgkmcnt(6)
    v_mfma_f32_32x32x16_bf16 v[16:31], v[128:131], v[132:135], v[16:31]
    s_waitcnt lgkmcnt(3)
    v_mfma_f32_32x32x16_bf16 v[16:31], v[96:99], v[100:103], v[16:31]
    s_waitcnt lgkmcnt(0)
    v_mfma_f32_32x32x16_bf16 v[16:31], v[104:107], v[108:111], v[16:31]
    s_and_b32 s51, s56, 1
    s_lshl_b32 s51, s51, 10
    s_lshr_b32 s52, s56, 1
    s_lshl_b32 s52, s52, 12
    s_add_u32 s51, s51, s52
    s_add_u32 s51, s51, 153600
    v_add_u32 v3, s51, v2
    v_mul_f32 v80, 0x3eb8aa3b, v80
    s_nop 3
    v_pk_mul_f32 v[16:17], v[16:17], v[80:81] op_sel_hi:[1,0]
    v_pk_mul_f32 v[18:19], v[18:19], v[80:81] op_sel_hi:[1,0]
    v_pk_mul_f32 v[20:21], v[20:21], v[80:81] op_sel_hi:[1,0]
    v_pk_mul_f32 v[22:23], v[22:23], v[80:81] op_sel_hi:[1,0]
    v_pk_mul_f32 v[24:25], v[24:25], v[80:81] op_sel_hi:[1,0]
    v_pk_mul_f32 v[26:27], v[26:27], v[80:81] op_sel_hi:[1,0]
    v_pk_mul_f32 v[28:29], v[28:29], v[80:81] op_sel_hi:[1,0]
    v_pk_mul_f32 v[30:31], v[30:31], v[80:81] op_sel_hi:[1,0]
    v_cvt_pk_bf16_f32 v16, v16, v17
    v_cvt_pk_bf16_f32 v17, v18, v19
    v_cvt_pk_bf16_f32 v18, v20, v21
    v_cvt_pk_bf16_f32 v19, v22, v23
    v_cvt_pk_bf16_f32 v20, v24, v25
    v_cvt_pk_bf16_f32 v21, v26, v27
    v_cvt_pk_bf16_f32 v22, v28, v29
    v_cvt_pk_bf16_f32 v23, v30, v31
    ds_write_b128 v3, v[16:19]
    ds_write_b128 v3, v[20:23] offset:2048
    s_waitcnt lgkmcnt(0)
    v_mov_b32 v3, 1
    s_mov_b64 exec, 1
    ds_add_u32 v6, v3 offset:72
    s_mov_b64 exec, -1
    s_lshl_b32 s51, s49, 3
    s_add_u32 s51, s51, s56
    s_lshl_b32 s51, s51, 3
    s_add_u32 s51, s51, s50
    s_lshl_b32 s51, s51, 10
    s_add_u32 s51, s51, 8388608
    s_add_u32 s52, s51, 32768
    v_mov_b64 v[156:157], -1
    v_mov_b64 v[158:159], -1
    buffer_store_dwordx4 v[156:159], v2, s[32:35], s51 offen sc1
    buffer_store_dwordx4 v[156:159], v2, s[32:35], s52 offen sc1
    s_cmp_lg_u32 s56, 3
    s_cbranch_scc1 L_nf2_13
    s_add_u32 s51, s51, 2097152
    s_add_u32 s52, s52, 2097152
    buffer_store_dwordx4 v[156:159], v2, s[32:35], s51 offen sc1
    buffer_store_dwordx4 v[156:159], v2, s[32:35], s52 offen sc1
L_nf2_13:
    s_setprio 2
    v_dot2_f32_bf16 v24, v16, v16, 0
    v_dot2_f32_bf16 v25, v20, v20, 0
    v_dot2_f32_bf16 v24, v17, v17, v24
    v_dot2_f32_bf16 v25, v21, v21, v25
    v_dot2_f32_bf16 v24, v18, v18, v24
    v_dot2_f32_bf16 v25, v22, v22, v25
    v_dot2_f32_bf16 v24, v19, v19, v24
    v_dot2_f32_bf16 v25, v23, v23, v25
    v_mov_b32 v28, 0
    v_mov_b32 v29, 0
    v_mov_b32 v30, 0
    v_mov_b32 v31, 0
    v_permlane32_swap_b32 v24, v25
    s_lshl_b32 s51, s56, 10
    v_add_f32 v24, v24, v25
    s_add_u32 s51, s51, 149504
    s_nop 1
    v_max_f32_dpp v24, v24, v24 row_ror:8 row_mask:0xf bank_mask:0xf
    s_nop 1
    v_max_f32_dpp v24, v24, v24 row_ror:4 row_mask:0xf bank_mask:0xf
    s_nop 1
    v_max_f32_dpp v24, v24, v24 row_ror:2 row_mask:0xf bank_mask:0xf
    s_nop 1
    v_max_f32_dpp v24, v24, v24 row_ror:1 row_mask:0xf bank_mask:0xf
    v_add_u32 v4, s51, v2
    s_mov_b32 exec_lo, 0x00010001
    s_mov_b32 exec_hi, 0x00010001
    ds_max_u32 v6, v24 offset:8
    s_mov_b64 exec, -1
    s_mov_b32 s3, 2097152
L_lw_14:
    ds_read_b32 v3, v6 offset:72
    s_sub_u32 s3, s3, 1
    s_waitcnt lgkmcnt(0)
    v_cmp_gt_u32 vcc, 4, v3
    s_cbranch_vccz L_lwd_15
    s_sleep 1
    s_cbranch_scc0 L_lw_14
L_lwd_15:
    ds_write_b128 v4, v[28:31]
    s_waitcnt vmcnt(0)
    s_waitcnt lgkmcnt(0)
    v_mov_b32 v3, 1
    s_mov_b64 exec, 1
    ds_add_u32 v6, v3 offset:40
    s_mov_b64 exec, -1
    s_setprio 2
    s_branch L_g1
L_attn:
    s_add_u32 s84, s53, 0
    s_and_b32 s84, s84, 63
    s_lshr_b32 s51, s84, 5
    s_mul_i32 s51, s51, 33280
    s_lshl_b32 s84, s84, 4
    s_add_u32 s84, s84, s51
    s_add_u32 s85, s53, 1
    s_and_b32 s85, s85, 63
    s_lshr_b32 s51, s85, 5
    s_mul_i32 s51, s51, 33280
    s_lshl_b32 s85, s85, 4
    s_add_u32 s85, s85, s51
    s_add_u32 s86, s53, 2
    s_and_b32 s86, s86, 63
    s_lshr_b32 s51, s86, 5
    s_mul_i32 s51, s51, 33280
    s_lshl_b32 s86, s86, 4
    s_add_u32 s86, s86, s51
    s_add_u32 s87, s53, 3
    s_and_b32 s87, s87, 63
    s_lshr_b32 s51, s87, 5
    s_mul_i32 s51, s51, 33280
    s_lshl_b32 s87, s87, 4
    s_add_u32 s87, s87, s51
    s_add_u32 s88, s53, 4
    s_and_b32 s88, s88, 63
    s_lshr_b32 s51, s88, 5
    s_mul_i32 s51, s51, 33280
    s_lshl_b32 s88, s88, 4
    s_add_u32 s88, s88, s51
    s_add_u32 s89, s53, 5
    s_and_b32 s89, s89, 63
    s_lshr_b32 s51, s89, 5
    s_mul_i32 s51, s51, 33280
    s_lshl_b32 s89, s89, 4
    s_add_u32 s89, s89, s51
    s_cmp_lt_u32 s48, 6
    s_cbranch_scc1 L_nopq_16
    s_lshr_b32 s52, s2, 3
    s_lshl_b32 s52, s52, 1
    s_add_u32 s51, s48, s52
    s_sub_u32 s51, s51, 6
    s_lshl_b32 s51, s51, 13
    v_lshl_add_u32 v10, v1, 7, s51
    global_load_dword v10, v10, s[6:7]
L_nopq_16:
    v_and_b32 v3, 15, v1
    v_cmp_eq_u32 vcc, 0, v3
    v_mov_b32 v4, 0x3f803f80
    v_and_b32 v3, 31, v1
    v_cndmask_b32 v52, 0, v4, vcc
    v_cndmask_b32 v53, 0, v4, vcc
    v_mov_b64 v[54:55], v[52:53]
    v_mov_b64 v[60:61], v[52:53]
    v_mov_b64 v[62:63], v[52:53]
    v_mov_b64 v[68:69], v[52:53]
    v_mov_b64 v[70:71], v[52:53]
    v_mov_b64 v[76:77], v[52:53]
    v_mov_b64 v[78:79], v[52:53]
    v_mov_b64 v[84:85], v[52:53]
    v_mov_b64 v[86:87], v[52:53]
    v_mov_b64 v[92:93], v[52:53]
    v_mov_b64 v[94:95], v[52:53]
    v_mov_b64 v[100:101], v[52:53]
    v_mov_b64 v[102:103], v[52:53]
    v_mov_b64 v[108:109], v[52:53]
    v_mov_b64 v[110:111], v[52:53]
    v_add_u32 v8, 153600, v2
    v_lshlrev_b32 v164, 7, v3
    s_lshl_b32 s51, s48, 10
    s_add_u32 s51, s51, 116736
    v_add_u32 v9, s51, v2
    s_lshr_b32 s91, s2, 1
    s_and_b32 s91, s91, 4
    s_xor_b32 s91, s91, s48
    s_lshl_b32 s95, s91, 12
    s_add_u32 s95, s95, 163840
    s_lshl_b32 s90, s91, 13
    s_add_u32 s91, s90, 4096
    s_add_u32 s92, s90, 65536
    s_add_u32 s93, s90, 69632
    v_and_b32 v3, 1, v1
    v_lshlrev_b32 v3, 4, v3
    v_mov_b32 v4, 0x3f80
    v_lshlrev_b32 v4, v3, v4
    v_lshrrev_b32 v3, 3, v1
    v_and_b32 v3, 4, v3
    v_xor_b32 v3, v3, v1
    v_and_b32 v3, 0x1e, v3
    v_cmp_eq_u32 vcc, 0, v3
    s_nop 1
    v_cndmask_b32 v160, 0, v4, vcc
    v_cmp_eq_u32 vcc, 2, v3
    s_nop 1
    v_cndmask_b32 v161, 0, v4, vcc
    v_cmp_eq_u32 vcc, 8, v3
    s_nop 1
    v_cndmask_b32 v162, 0, v4, vcc
    v_cmp_eq_u32 vcc, 10, v3
    s_nop 1
    v_cndmask_b32 v163, 0, v4, vcc
    s_and_b32 s49, s2, 7
    s_lshl_b32 s49, s49, 2
    s_lshr_b32 s50, s2, 6
    s_add_u32 s49, s49, s50
    s_lshr_b32 s50, s2, 3
    s_and_b32 s50, s50, 7
    v_mov_b32 v6, 161792
    s_mov_b32 s57, 0x3f803f80
    s_mov_b64 s[28:29], s[4:5]
    s_mov_b32 s30, 0x200000
    s_mov_b32 s31, 0x20000
    s_mov_b64 s[32:33], s[26:27]
    s_mov_b32 s34, 0x2000000
    s_mov_b32 s35, 0x20000
    s_mov_b64 s[40:41], s[22:23]
    s_mov_b32 s42, 0x200000
    s_mov_b32 s43, 0x20000
    v_mul_u32_u24 v150, 528, v1
    v_mov_b32 v152, 0x00003f80
    v_mov_b32 v153, 0x3f800000
    v_lshrrev_b32 v154, 4, v1
    v_add_u32 v154, s53, v154
    v_and_b32 v154, 63, v154
    v_lshlrev_b32 v154, 2, v154
    v_lshrrev_b32 v155, 5, v1
    v_add3_u32 v155, s53, 4, v155
    v_and_b32 v155, 63, v155
    v_lshlrev_b32 v155, 2, v155
    s_cmp_lt_u32 s48, 6
    s_cbranch_scc1 L_xw_17
    s_waitcnt vmcnt(1)
    s_branch L_xw2_18
L_xw_17:
    s_waitcnt vmcnt(0)
L_xw2_18:
    s_setprio 1
    v_dot2_f32_bf16 v136, v112, s57, 0
    v_dot2_f32_bf16 v137, v116, s57, 0
    v_dot2_f32_bf16 v136, v113, s57, v136
    v_dot2_f32_bf16 v137, v117, s57, v137
    v_dot2_f32_bf16 v136, v114, s57, v136
    v_dot2_f32_bf16 v137, v118, s57, v137
    v_dot2_f32_bf16 v136, v115, s57, v136
    v_dot2_f32_bf16 v137, v119, s57, v137
    v_dot2_f32_bf16 v138, v120, s57, 0
    v_dot2_f32_bf16 v139, v124, s57, 0
    v_dot2_f32_bf16 v138, v121, s57, v138
    v_dot2_f32_bf16 v139, v125, s57, v139
    v_dot2_f32_bf16 v138, v122, s57, v138
    v_dot2_f32_bf16 v139, v126, s57, v139
    v_dot2_f32_bf16 v138, v123, s57, v138
    v_dot2_f32_bf16 v139, v127, s57, v139
    v_dot2_f32_bf16 v140, v128, s57, 0
    v_dot2_f32_bf16 v141, v132, s57, 0
    v_dot2_f32_bf16 v140, v129, s57, v140
    v_dot2_f32_bf16 v141, v133, s57, v141
    v_dot2_f32_bf16 v140, v130, s57, v140
    v_dot2_f32_bf16 v141, v134, s57, v141
    v_dot2_f32_bf16 v140, v131, s57, v140
    v_dot2_f32_bf16 v141, v135, s57, v141
    s_nop 2
    v_permlane32_swap_b32 v136, v138
    v_permlane32_swap_b32 v137, v139
    v_permlane32_swap_b32 v140, v141
    v_add_f32 v136, v136, v138
    v_add_f32 v137, v137, v139
    v_add_f32 v140, v140, v141
    v_mov_b32 v141, v140
    s_nop 1
    v_permlane16_swap_b32 v136, v137
    v_permlane16_swap_b32 v140, v141
    s_nop 0
    v_add_f32 v136, v136, v137
    v_add_f32 v140, v140, v141
    s_nop 0
    v_add_f32_dpp v136, v136, v136 row_ror:8 row_mask:0xf bank_mask:0xf
    v_add_f32_dpp v140, v140, v140 row_ror:8 row_mask:0xf bank_mask:0xf
    s_nop 0
    v_add_f32_dpp v136, v136, v136 row_ror:4 row_mask:0xf bank_mask:0xf
    v_add_f32_dpp v140, v140, v140 row_ror:4 row_mask:0xf bank_mask:0xf
    s_nop 0
    v_add_f32_dpp v136, v136, v136 row_ror:2 row_mask:0xf bank_mask:0xf
    v_add_f32_dpp v140, v140, v140 row_ror:2 row_mask:0xf bank_mask:0xf
    s_nop 0
    v_add_f32_dpp v136, v136, v136 row_ror:1 row_mask:0xf bank_mask:0xf
    v_add_f32_dpp v140, v140, v140 row_ror:1 row_mask:0xf bank_mask:0xf
    v_mul_f32 v136, 0xbb000000, v136
    v_mul_f32 v140, 0xbb000000, v140
    v_cvt_pk_bf16_f32 v148, v136, v136
    v_cvt_pk_bf16_f32 v149, v140, v140
    v_lshlrev_b32 v148, 16, v148
    v_lshlrev_b32 v149, 16, v149
    s_nop 0
    v_readlane_b32 s60, v148, 0
    v_readlane_b32 s61, v148, 16
    v_readlane_b32 s62, v148, 32
    v_readlane_b32 s63, v148, 48
    v_readlane_b32 s64, v149, 0
    v_readlane_b32 s65, v149, 32
    v_dot2_f32_bf16 v16, v112, v152, s60
    v_dot2_f32_bf16 v17, v112, v153, s60
    v_dot2_f32_bf16 v18, v113, v152, s60
    v_dot2_f32_bf16 v19, v113, v153, s60
    v_dot2_f32_bf16 v20, v114, v152, s60
    v_dot2_f32_bf16 v21, v114, v153, s60
    v_dot2_f32_bf16 v22, v115, v152, s60
    v_dot2_f32_bf16 v23, v115, v153, s60
    v_dot2_f32_bf16 v24, v116, v152, s61
    v_dot2_f32_bf16 v25, v116, v153, s61
    v_dot2_f32_bf16 v26, v117, v152, s61
    v_dot2_f32_bf16 v27, v117, v153, s61
    v_dot2_f32_bf16 v28, v118, v152, s61
    v_dot2_f32_bf16 v29, v118, v153, s61
    v_dot2_f32_bf16 v30, v119, v152, s61
    v_dot2_f32_bf16 v31, v119, v153, s61
    v_add_u32 v151, s84, v150
    v_cvt_pk_bf16_f32 v112, v16, v17
    v_cvt_pk_bf16_f32 v113, v18, v19
    v_cvt_pk_bf16_f32 v114, v20, v21
    v_cvt_pk_bf16_f32 v115, v22, v23
    ds_write_b128 v151, v[112:115]
    v_dot2_f32_bf16 v16, v120, v152, s62
    v_dot2_f32_bf16 v17, v120, v153, s62
    v_dot2_f32_bf16 v18, v121, v152, s62
    v_dot2_f32_bf16 v19, v121, v153, s62
    v_dot2_f32_bf16 v20, v122, v152, s62
    v_dot2_f32_bf16 v21, v122, v153, s62
    v_dot2_f32_bf16 v22, v123, v152, s62
    v_dot2_f32_bf16 v23, v123, v153, s62
    v_add_u32 v151, s85, v150
    v_cvt_pk_bf16_f32 v116, v24, v25
    v_cvt_pk_bf16_f32 v117, v26, v27
    v_cvt_pk_bf16_f32 v118, v28, v29
    v_cvt_pk_bf16_f32 v119, v30, v31
    ds_write_b128 v151, v[116:119]
    v_dot2_f32_bf16 v24, v124, v152, s63
    v_dot2_f32_bf16 v25, v124, v153, s63
    v_dot2_f32_bf16 v26, v125, v152, s63
    v_dot2_f32_bf16 v27, v125, v153, s63
    v_dot2_f32_bf16 v28, v126, v152, s63
    v_dot2_f32_bf16 v29, v126, v153, s63
    v_dot2_f32_bf16 v30, v127, v152, s63
    v_dot2_f32_bf16 v31, v127, v153, s63
    v_add_u32 v151, s86, v150
    v_cvt_pk_bf16_f32 v120, v16, v17
    v_cvt_pk_bf16_f32 v121, v18, v19
    v_cvt_pk_bf16_f32 v122, v20, v21
    v_cvt_pk_bf16_f32 v123, v22, v23
    ds_write_b128 v151, v[120:123]
    v_dot2_f32_bf16 v16, v128, v152, s64
    v_dot2_f32_bf16 v17, v128, v153, s64
    v_dot2_f32_bf16 v18, v129, v152, s64
    v_dot2_f32_bf16 v19, v129, v153, s64
    v_dot2_f32_bf16 v20, v130, v152, s64
    v_dot2_f32_bf16 v21, v130, v153, s64
    v_dot2_f32_bf16 v22, v131, v152, s64
    v_dot2_f32_bf16 v23, v131, v153, s64
    v_add_u32 v151, s87, v150
    v_cvt_pk_bf16_f32 v124, v24, v25
    v_cvt_pk_bf16_f32 v125, v26, v27
    v_cvt_pk_bf16_f32 v126, v28, v29
    v_cvt_pk_bf16_f32 v127, v30, v31
    ds_write_b128 v151, v[124:127]
    v_dot2_f32_bf16 v24, v132, v152, s65
    v_dot2_f32_bf16 v25, v132, v153, s65
    v_dot2_f32_bf16 v26, v133, v152, s65
    v_dot2_f32_bf16 v27, v133, v153, s65
    v_dot2_f32_bf16 v28, v134, v152, s65
    v_dot2_f32_bf16 v29, v134, v153, s65
    v_dot2_f32_bf16 v30, v135, v152, s65
    v_dot2_f32_bf16 v31, v135, v153, s65
    v_add_u32 v151, s88, v150
    v_cvt_pk_bf16_f32 v128, v16, v17
    v_cvt_pk_bf16_f32 v129, v18, v19
    v_cvt_pk_bf16_f32 v130, v20, v21
    v_cvt_pk_bf16_f32 v131, v22, v23
    ds_write_b128 v151, v[128:131]
    v_add_u32 v151, s89, v150
    v_cvt_pk_bf16_f32 v132, v24, v25
    v_cvt_pk_bf16_f32 v133, v26, v27
    v_cvt_pk_bf16_f32 v134, v28, v29
    v_cvt_pk_bf16_f32 v135, v30, v31
    ds_write_b128 v151, v[132:135]
    s_setprio 0
    v_dot2_f32_bf16 v142, v112, v112, 0
    v_dot2_f32_bf16 v143, v116, v116, 0
    v_dot2_f32_bf16 v144, v120, v120, 0
    v_dot2_f32_bf16 v145, v124, v124, 0
    v_dot2_f32_bf16 v146, v128, v128, 0
    v_dot2_f32_bf16 v147, v132, v132, 0
    v_dot2_f32_bf16 v142, v113, v113, v142
    v_dot2_f32_bf16 v143, v117, v117, v143
    v_dot2_f32_bf16 v144, v121, v121, v144
    v_dot2_f32_bf16 v145, v125, v125, v145
    v_dot2_f32_bf16 v146, v129, v129, v146
    v_dot2_f32_bf16 v147, v133, v133, v147
    v_dot2_f32_bf16 v142, v114, v114, v142
    v_dot2_f32_bf16 v143, v118, v118, v143
    v_dot2_f32_bf16 v144, v122, v122, v144
    v_dot2_f32_bf16 v145, v126, v126, v145
    v_dot2_f32_bf16 v146, v130, v130, v146
    v_dot2_f32_bf16 v147, v134, v134, v147
    v_dot2_f32_bf16 v142, v115, v115, v142
    v_dot2_f32_bf16 v143, v119, v119, v143
    v_dot2_f32_bf16 v144, v123, v123, v144
    v_dot2_f32_bf16 v145, v127, v127, v145
    v_dot2_f32_bf16 v146, v131, v131, v146
    v_dot2_f32_bf16 v147, v135, v135, v147
    s_nop 2
    v_permlane32_swap_b32 v142, v144
    v_permlane32_swap_b32 v143, v145
    v_permlane32_swap_b32 v146, v147
    v_add_f32 v142, v142, v144
    v_add_f32 v143, v143, v145
    v_add_f32 v146, v146, v147
    v_mov_b32 v147, v146
    s_nop 1
    v_permlane16_swap_b32 v142, v143
    v_permlane16_swap_b32 v146, v147
    s_nop 0
    v_add_f32 v142, v142, v143
    v_add_f32 v146, v146, v147
    s_nop 0
    v_add_f32_dpp v142, v142, v142 row_ror:8 row_mask:0xf bank_mask:0xf
    v_add_f32_dpp v146, v146, v146 row_ror:8 row_mask:0xf bank_mask:0xf
    s_nop 0
    v_add_f32_dpp v142, v142, v142 row_ror:4 row_mask:0xf bank_mask:0xf
    v_add_f32_dpp v146, v146, v146 row_ror:4 row_mask:0xf bank_mask:0xf
    s_nop 0
    v_add_f32_dpp v142, v142, v142 row_ror:2 row_mask:0xf bank_mask:0xf
    v_add_f32_dpp v146, v146, v146 row_ror:2 row_mask:0xf bank_mask:0xf
    s_nop 0
    v_add_f32_dpp v142, v142, v142 row_ror:1 row_mask:0xf bank_mask:0xf
    v_add_f32_dpp v146, v146, v146 row_ror:1 row_mask:0xf bank_mask:0xf
    v_sub_f32 v136, v136, v148
    v_sub_f32 v140, v140, v149
    v_mul_f32 v142, 0x3b000000, v142
    v_mul_f32 v146, 0x3b000000, v146
    v_fma_f32 v142, -v136, v136, v142
    v_fma_f32 v146, -v140, v140, v146
    v_max_f32 v142, 0, v142
    v_max_f32 v146, 0, v146
    v_cvt_pk_bf16_f32 v142, v142, v142
    v_cvt_pk_bf16_f32 v146, v146, v146
    v_lshlrev_b32 v142, 16, v142
    v_lshlrev_b32 v146, 16, v146
    v_add_f32 v142, 0x3727c5ac, v142
    v_add_f32 v146, 0x3727c5ac, v146
    v_cvt_pk_bf16_f32 v142, v142, v142
    v_cvt_pk_bf16_f32 v146, v146, v146
    v_lshlrev_b32 v142, 16, v142
    v_lshlrev_b32 v146, 16, v146
    v_sqrt_f32 v142, v142
    v_sqrt_f32 v146, v146
    s_nop 0
    v_cvt_pk_bf16_f32 v142, v142, v142
    v_cvt_pk_bf16_f32 v146, v146, v146
    v_lshlrev_b32 v142, 16, v142
    v_lshlrev_b32 v146, 16, v146
    v_rcp_f32 v142, v142
    v_rcp_f32 v146, v146
    v_add_u32 v154, 163072, v154
    v_add_u32 v155, 163072, v155
    ds_write_b32 v154, v142
    ds_write_b32 v155, v146
    s_waitcnt lgkmcnt(0)
    v_mov_b32 v3, 1
    s_mov_b64 exec, 1
    ds_add_u32 v6, v3 offset:100
    s_mov_b64 exec, -1
    s_mov_b32 s3, 2097152
L_lw_19:
    ds_read_b32 v4, v6 offset:84
    s_sub_u32 s3, s3, 1
    s_waitcnt lgkmcnt(0)
    v_cmp_gt_u32 vcc, 4, v4
    s_cbranch_vccz L_lwd_20
    s_sleep 1
    s_cbranch_scc0 L_lw_19
L_lwd_20:
    ds_read_b64 v[112:113], v6 offset:64
    s_waitcnt lgkmcnt(0)
    v_readfirstlane_b32 s58, v112
    v_readfirstlane_b32 s59, v113
    s_mov_b32 s3, 262144
L_kp_21:
    buffer_load_dwordx4 v[112:115], v164, s[32:35], s95 offen sc1
    s_waitcnt vmcnt(0)
    v_cmp_ne_u64 vcc, s[58:59], v[112:113]
    v_cmp_ne_u32 s[62:63], v112, v115
    s_or_b64 vcc, vcc, s[62:63]
    s_cbranch_vccz L_kpd_22
    s_sub_u32 s3, s3, 1
    s_sleep 1
    s_cbranch_scc0 L_kp_21
L_kpd_22:
    v_mov_b32 v5, v114
    s_cmp_lt_u32 s48, 4
    s_cbranch_scc1 L_old_23
    s_mov_b32 s3, 2097152
L_lw_24:
    ds_read_b32 v4, v6 offset:48
    s_sub_u32 s3, s3, 1
    s_waitcnt lgkmcnt(0)
    v_cmp_gt_u32 vcc, 4, v4
    s_cbranch_vccz L_lwd_25
    s_sleep 1
    s_cbranch_scc0 L_lw_24
L_lwd_25:
L_old_23:
    buffer_load_dwordx4 v[16:19], v2, s[32:35], s90 offen offset:0 sc1
    buffer_load_dwordx4 v[20:23], v2, s[32:35], s90 offen offset:1024 sc1
    buffer_load_dwordx4 v[48:51], v2, s[32:35], s92 offen offset:0 sc1
    buffer_load_dwordx4 v[24:27], v2, s[32:35], s90 offen offset:2048 sc1
    buffer_load_dwordx4 v[56:59], v2, s[32:35], s92 offen offset:1024 sc1
    buffer_load_dwordx4 v[28:31], v2, s[32:35], s90 offen offset:3072 sc1
    buffer_load_dwordx4 v[64:67], v2, s[32:35], s92 offen offset:2048 sc1
    buffer_load_dwordx4 v[32:35], v2, s[32:35], s91 offen offset:0 sc1
    buffer_load_dwordx4 v[72:75], v2, s[32:35], s92 offen offset:3072 sc1
    buffer_load_dwordx4 v[36:39], v2, s[32:35], s91 offen offset:1024 sc1
    buffer_load_dwordx4 v[80:83], v2, s[32:35], s93 offen offset:0 sc1
    buffer_load_dwordx4 v[40:43], v2, s[32:35], s91 offen offset:2048 sc1
    buffer_load_dwordx4 v[88:91], v2, s[32:35], s93 offen offset:1024 sc1
    buffer_load_dwordx4 v[44:47], v2, s[32:35], s91 offen offset:3072 sc1
    buffer_load_dwordx4 v[96:99], v2, s[32:35], s93 offen offset:2048 sc1
    buffer_load_dwordx4 v[104:107], v2, s[32:35], s93 offen offset:3072 sc1
    s_waitcnt lgkmcnt(0)
    v_mov_b32 v3, 1
    s_mov_b64 exec, 1
    ds_add_u32 v6, v3 offset:48
    s_mov_b64 exec, -1
    s_mov_b32 s3, 2097152
L_lw_26:
    ds_read_b32 v3, v6 offset:72
    s_sub_u32 s3, s3, 1
    s_waitcnt lgkmcnt(0)
    v_cmp_gt_u32 vcc, 4, v3
    s_cbranch_vccz L_lwd_27
    s_sleep 1
    s_cbranch_scc0 L_lw_26
L_lwd_27:
    ds_read_b128 v[12:15], v8
    s_waitcnt vmcnt(15)
    s_waitcnt lgkmcnt(0)
    v_mfma_f32_32x32x16_bf16 v[112:127], v[16:19], v[12:15], 0
    s_nop 11
    s_waitcnt vmcnt(14)
    s_setprio 3
    v_exp_f32 v112, v112
    v_exp_f32 v113, v113
    v_exp_f32 v114, v114
    v_exp_f32 v115, v115
    v_exp_f32 v116, v116
    v_exp_f32 v117, v117
    v_mfma_f32_32x32x16_bf16 v[128:143], v[20:23], v[12:15], 0
    s_setprio 1
    v_cvt_pk_bf16_f32 v112, v112, v113
    v_cvt_pk_bf16_f32 v113, v114, v115
    v_exp_f32 v118, v118
    v_exp_f32 v119, v119
    v_cvt_pk_bf16_f32 v114, v116, v117
    v_exp_f32 v120, v120
    v_exp_f32 v121, v121
    v_cvt_pk_bf16_f32 v115, v118, v119
    v_exp_f32 v122, v122
    v_exp_f32 v123, v123
    v_cvt_pk_bf16_f32 v116, v120, v121
    v_exp_f32 v124, v124
    v_exp_f32 v125, v125
    v_cvt_pk_bf16_f32 v117, v122, v123
    s_waitcnt vmcnt(13)
    v_permlane16_swap_b32 v48, v52
    v_permlane16_swap_b32 v49, v53
    v_permlane16_swap_b32 v50, v54
    v_permlane16_swap_b32 v51, v55
    v_exp_f32 v126, v126
    v_exp_f32 v127, v127
    v_cvt_pk_bf16_f32 v118, v124, v125
    v_cvt_pk_bf16_f32 v119, v126, v127
    s_waitcnt vmcnt(12)
    s_setprio 3
    v_mfma_f32_32x32x16_bf16 v[144:159], v[48:51], v[112:115], 0
    v_exp_f32 v128, v128
    v_exp_f32 v129, v129
    v_exp_f32 v130, v130
    v_mfma_f32_32x32x16_bf16 v[144:159], v[52:55], v[116:119], v[144:159]
    v_exp_f32 v131, v131
    v_exp_f32 v132, v132
    v_exp_f32 v133, v133
    v_mfma_f32_32x32x16_bf16 v[112:127], v[24:27], v[12:15], 0
    s_setprio 1
    v_cvt_pk_bf16_f32 v128, v128, v129
    v_cvt_pk_bf16_f32 v129, v130, v131
    v_exp_f32 v134, v134
    v_exp_f32 v135, v135
    v_cvt_pk_bf16_f32 v130, v132, v133
    v_exp_f32 v136, v136
    v_exp_f32 v137, v137
    v_cvt_pk_bf16_f32 v131, v134, v135
    v_exp_f32 v138, v138
    v_exp_f32 v139, v139
    v_cvt_pk_bf16_f32 v132, v136, v137
    v_exp_f32 v140, v140
    v_exp_f32 v141, v141
    v_cvt_pk_bf16_f32 v133, v138, v139
    s_waitcnt vmcnt(11)
    v_permlane16_swap_b32 v56, v60
    v_permlane16_swap_b32 v57, v61
    v_permlane16_swap_b32 v58, v62
    v_permlane16_swap_b32 v59, v63
    v_exp_f32 v142, v142
    v_exp_f32 v143, v143
    v_cvt_pk_bf16_f32 v134, v140, v141
    v_cvt_pk_bf16_f32 v135, v142, v143
    s_waitcnt vmcnt(10)
    s_setprio 3
    v_mfma_f32_32x32x16_bf16 v[144:159], v[56:59], v[128:131], v[144:159]
    v_exp_f32 v112, v112
    v_exp_f32 v113, v113
    v_exp_f32 v114, v114
    v_mfma_f32_32x32x16_bf16 v[144:159], v[60:63], v[132:135], v[144:159]
    v_exp_f32 v115, v115
    v_exp_f32 v116, v116
    v_exp_f32 v117, v117
    v_mfma_f32_32x32x16_bf16 v[128:143], v[28:31], v[12:15], 0
    s_setprio 1
    v_cvt_pk_bf16_f32 v112, v112, v113
    v_cvt_pk_bf16_f32 v113, v114, v115
    v_exp_f32 v118, v118
    v_exp_f32 v119, v119
    v_cvt_pk_bf16_f32 v114, v116, v117
    v_exp_f32 v120, v120
    v_exp_f32 v121, v121
    v_cvt_pk_bf16_f32 v115, v118, v119
    v_exp_f32 v122, v122
    v_exp_f32 v123, v123
    v_cvt_pk_bf16_f32 v116, v120, v121
    v_exp_f32 v124, v124
    v_exp_f32 v125, v125
    v_cvt_pk_bf16_f32 v117, v122, v123
    s_waitcnt vmcnt(9)
    v_permlane16_swap_b32 v64, v68
    v_permlane16_swap_b32 v65, v69
    v_permlane16_swap_b32 v66, v70
    v_permlane16_swap_b32 v67, v71
    v_exp_f32 v126, v126
    v_exp_f32 v127, v127
    v_cvt_pk_bf16_f32 v118, v124, v125
    v_cvt_pk_bf16_f32 v119, v126, v127
    s_waitcnt vmcnt(8)
    s_setprio 3
    v_mfma_f32_32x32x16_bf16 v[144:159], v[64:67], v[112:115], v[144:159]
    v_exp_f32 v128, v128
    v_exp_f32 v129, v129
    v_exp_f32 v130, v130
    v_mfma_f32_32x32x16_bf16 v[144:159], v[68:71], v[116:119], v[144:159]
    v_exp_f32 v131, v131
    v_exp_f32 v132, v132
    v_exp_f32 v133, v133
    v_mfma_f32_32x32x16_bf16 v[112:127], v[32:35], v[12:15], 0
    s_setprio 1
    v_cvt_pk_bf16_f32 v128, v128, v129
    v_cvt_pk_bf16_f32 v129, v130, v131
    v_exp_f32 v134, v134
    v_exp_f32 v135, v135
    v_cvt_pk_bf16_f32 v130, v132, v133
    v_exp_f32 v136, v136
    v_exp_f32 v137, v137
    v_cvt_pk_bf16_f32 v131, v134, v135
    v_exp_f32 v138, v138
    v_exp_f32 v139, v139
    v_cvt_pk_bf16_f32 v132, v136, v137
    v_exp_f32 v140, v140
    v_exp_f32 v141, v141
    v_cvt_pk_bf16_f32 v133, v138, v139
    s_waitcnt vmcnt(7)
    v_permlane16_swap_b32 v72, v76
    v_permlane16_swap_b32 v73, v77
    v_permlane16_swap_b32 v74, v78
    v_permlane16_swap_b32 v75, v79
    v_exp_f32 v142, v142
    v_exp_f32 v143, v143
    v_cvt_pk_bf16_f32 v134, v140, v141
    v_cvt_pk_bf16_f32 v135, v142, v143
    s_waitcnt vmcnt(6)
    s_setprio 3
    v_mfma_f32_32x32x16_bf16 v[144:159], v[72:75], v[128:131], v[144:159]
    v_exp_f32 v112, v112
    v_exp_f32 v113, v113
    v_exp_f32 v114, v114
    v_mfma_f32_32x32x16_bf16 v[144:159], v[76:79], v[132:135], v[144:159]
    v_exp_f32 v115, v115
    v_exp_f32 v116, v116
    v_exp_f32 v117, v117
    v_mfma_f32_32x32x16_bf16 v[128:143], v[36:39], v[12:15], 0
    s_setprio 1
    v_cvt_pk_bf16_f32 v112, v112, v113
    v_cvt_pk_bf16_f32 v113, v114, v115
    v_exp_f32 v118, v118
    v_exp_f32 v119, v119
    v_cvt_pk_bf16_f32 v114, v116, v117
    v_exp_f32 v120, v120
    v_exp_f32 v121, v121
    v_cvt_pk_bf16_f32 v115, v118, v119
    v_exp_f32 v122, v122
    v_exp_f32 v123, v123
    v_cvt_pk_bf16_f32 v116, v120, v121
    v_exp_f32 v124, v124
    v_exp_f32 v125, v125
    v_cvt_pk_bf16_f32 v117, v122, v123
    s_waitcnt vmcnt(5)
    v_permlane16_swap_b32 v80, v84
    v_permlane16_swap_b32 v81, v85
    v_permlane16_swap_b32 v82, v86
    v_permlane16_swap_b32 v83, v87
    v_exp_f32 v126, v126
    v_exp_f32 v127, v127
    v_cvt_pk_bf16_f32 v118, v124, v125
    v_cvt_pk_bf16_f32 v119, v126, v127
    s_waitcnt vmcnt(4)
    s_setprio 3
    v_mfma_f32_32x32x16_bf16 v[144:159], v[80:83], v[112:115], v[144:159]
    v_exp_f32 v128, v128
    v_exp_f32 v129, v129
    v_exp_f32 v130, v130
    v_mfma_f32_32x32x16_bf16 v[144:159], v[84:87], v[116:119], v[144:159]
    v_exp_f32 v131, v131
    v_exp_f32 v132, v132
    v_exp_f32 v133, v133
    v_mfma_f32_32x32x16_bf16 v[112:127], v[40:43], v[12:15], 0
    s_setprio 1
    v_cvt_pk_bf16_f32 v128, v128, v129
    v_cvt_pk_bf16_f32 v129, v130, v131
    v_exp_f32 v134, v134
    v_exp_f32 v135, v135
    v_cvt_pk_bf16_f32 v130, v132, v133
    v_exp_f32 v136, v136
    v_exp_f32 v137, v137
    v_cvt_pk_bf16_f32 v131, v134, v135
    v_exp_f32 v138, v138
    v_exp_f32 v139, v139
    v_cvt_pk_bf16_f32 v132, v136, v137
    v_exp_f32 v140, v140
    v_exp_f32 v141, v141
    v_cvt_pk_bf16_f32 v133, v138, v139
    s_waitcnt vmcnt(3)
    v_permlane16_swap_b32 v88, v92
    v_permlane16_swap_b32 v89, v93
    v_permlane16_swap_b32 v90, v94
    v_permlane16_swap_b32 v91, v95
    v_exp_f32 v142, v142
    v_exp_f32 v143, v143
    v_cvt_pk_bf16_f32 v134, v140, v141
    v_cvt_pk_bf16_f32 v135, v142, v143
    s_waitcnt vmcnt(2)
    s_setprio 3
    v_mfma_f32_32x32x16_bf16 v[144:159], v[88:91], v[128:131], v[144:159]
    v_exp_f32 v112, v112
    v_exp_f32 v113, v113
    v_exp_f32 v114, v114
    v_mfma_f32_32x32x16_bf16 v[144:159], v[92:95], v[132:135], v[144:159]
    v_exp_f32 v115, v115
    v_exp_f32 v116, v116
    v_exp_f32 v117, v117
    v_mfma_f32_32x32x16_bf16 v[128:143], v[44:47], v[12:15], 0
    s_setprio 1
    ds_read_b128 v[12:15], v8 offset:1024
    v_cvt_pk_bf16_f32 v112, v112, v113
    v_cvt_pk_bf16_f32 v113, v114, v115
    v_exp_f32 v118, v118
    v_exp_f32 v119, v119
    v_cvt_pk_bf16_f32 v114, v116, v117
    v_exp_f32 v120, v120
    v_exp_f32 v121, v121
    v_cvt_pk_bf16_f32 v115, v118, v119
    v_exp_f32 v122, v122
    v_exp_f32 v123, v123
    v_cvt_pk_bf16_f32 v116, v120, v121
    v_exp_f32 v124, v124
    v_exp_f32 v125, v125
    v_cvt_pk_bf16_f32 v117, v122, v123
    s_waitcnt vmcnt(1)
    v_permlane16_swap_b32 v96, v100
    v_permlane16_swap_b32 v97, v101
    v_permlane16_swap_b32 v98, v102
    v_permlane16_swap_b32 v99, v103
    v_exp_f32 v126, v126
    v_exp_f32 v127, v127
    v_cvt_pk_bf16_f32 v118, v124, v125
    v_cvt_pk_bf16_f32 v119, v126, v127
    s_waitcnt lgkmcnt(0)
    s_setprio 3
    v_mfma_f32_32x32x16_bf16 v[144:159], v[96:99], v[112:115], v[144:159]
    v_exp_f32 v128, v128
    v_exp_f32 v129, v129
    v_exp_f32 v130, v130
    v_mfma_f32_32x32x16_bf16 v[144:159], v[100:103], v[116:119], v[144:159]
    v_exp_f32 v131, v131
    v_exp_f32 v132, v132
    v_exp_f32 v133, v133
    v_mfma_f32_32x32x16_bf16 v[112:127], v[16:19], v[12:15], 0
    s_setprio 1
    v_cvt_pk_bf16_f32 v128, v128, v129
    v_cvt_pk_bf16_f32 v129, v130, v131
    v_exp_f32 v134, v134
    v_exp_f32 v135, v135
    v_cvt_pk_bf16_f32 v130, v132, v133
    v_exp_f32 v136, v136
    v_exp_f32 v137, v137
    v_cvt_pk_bf16_f32 v131, v134, v135
    v_exp_f32 v138, v138
    v_exp_f32 v139, v139
    v_cvt_pk_bf16_f32 v132, v136, v137
    v_exp_f32 v140, v140
    v_exp_f32 v141, v141
    v_cvt_pk_bf16_f32 v133, v138, v139
    s_waitcnt vmcnt(0)
    v_permlane16_swap_b32 v104, v108
    v_permlane16_swap_b32 v105, v109
    v_permlane16_swap_b32 v106, v110
    v_permlane16_swap_b32 v107, v111
    v_exp_f32 v142, v142
    v_exp_f32 v143, v143
    v_cvt_pk_bf16_f32 v134, v140, v141
    v_cvt_pk_bf16_f32 v135, v142, v143
    v_add_u32 v8, 1024, v8
    s_mov_b32 s3, 2097152
L_lw_28:
    ds_read_b32 v3, v6 offset:40
    s_sub_u32 s3, s3, 1
    s_waitcnt lgkmcnt(0)
    v_cmp_gt_u32 vcc, 4, v3
    s_cbranch_vccz L_lwd_29
    s_sleep 1
    s_cbranch_scc0 L_lw_28
L_lwd_29:
    ds_read_b32 v4, v6 offset:8
    s_waitcnt vmcnt(0) lgkmcnt(0)
    v_lshlrev_b32 v7, 3, v1
    v_add_u32 v7, 147456, v7
    v_mov_b32 v10, 0
    v_mov_b32 v11, 0x3ff00000
    s_mov_b32 s85, 1075576832
    s_mov_b32 s84, 0
    s_mov_b32 s88, 0
    v_mul_f32 v5, v5, v4
    v_cmp_nge_f32 vcc, 0x44c80000, v5
    s_cbranch_vccz L_bok_30
    s_waitcnt lgkmcnt(0)
    v_mov_b32 v3, 1
    s_mov_b64 exec, 1
    ds_add_u32 v6, v3 offset:12
    s_mov_b64 exec, -1
    s_waitcnt lgkmcnt(0)
    v_mov_b32 v3, 1
    s_mov_b64 exec, 1
    ds_add_u32 v6, v3 offset:92
    s_mov_b64 exec, -1
    v_mov_b32 v11, 0x40700000
    s_mov_b32 s85, -1
L_bok_30:
    s_waitcnt lgkmcnt(0)
    v_mov_b32 v3, 1
    s_mov_b64 exec, 1
    ds_add_u32 v6, v3 offset:76
    s_mov_b64 exec, -1
    s_cmp_lt_u32 s48, 4
    s_cbranch_scc1 L_aloopb_32
.p2align 6
L_aloopa_31:
    s_setprio 3
    v_mfma_f32_32x32x16_bf16 v[144:159], v[104:107], v[128:131], v[144:159]
    v_exp_f32 v112, v112
    v_exp_f32 v113, v113
    v_exp_f32 v114, v114
    v_mfma_f32_32x32x16_bf16 v[144:159], v[108:111], v[132:135], v[144:159]
    v_exp_f32 v115, v115
    v_exp_f32 v116, v116
    v_exp_f32 v117, v117
    v_mfma_f32_32x32x16_bf16 v[128:143], v[20:23], v[12:15], 0
    s_setprio 1
    ds_read_b32 v3, v7 offset:264
    v_cvt_pk_bf16_f32 v112, v112, v113
    v_cvt_pk_bf16_f32 v113, v114, v115
    v_exp_f32 v118, v118
    v_exp_f32 v119, v119
    v_cvt_pk_bf16_f32 v114, v116, v117
    v_add_u32 v4, s88, v9
    v_exp_f32 v120, v120
    v_exp_f32 v121, v121
    v_cvt_pk_bf16_f32 v156, v144, v145
    v_cvt_pk_bf16_f32 v115, v118, v119
    v_cvt_pk_bf16_f32 v157, v146, v147
    v_exp_f32 v122, v122
    v_cvt_pk_bf16_f32 v158, v148, v149
    v_exp_f32 v123, v123
    v_cvt_pk_bf16_f32 v159, v150, v151
    v_cvt_pk_bf16_f32 v116, v120, v121
    s_waitcnt lgkmcnt(0)
    v_readfirstlane_b32 s51, v3
    v_exp_f32 v124, v124
    v_exp_f32 v125, v125
    s_cmp_lt_u32 s84, 4
    s_cselect_b32 s51, 1, s51
    s_cmp_lg_u32 s51, 0
    s_cbranch_scc1 L_sf_34
    s_call_b64 s[86:87], L_wslot
L_sf_34:
    ds_write_b128 v4, v[156:159]
    s_mov_b32 exec_hi, 0
    v_cvt_f64_f32 v[10:11], v152
    s_mov_b32 exec_hi, 1
    ds_add_f64 v7, v[10:11] offset:2048
    s_mov_b32 exec_hi, -1
    v_cvt_pk_bf16_f32 v117, v122, v123
    v_exp_f32 v126, v126
    v_exp_f32 v127, v127
    v_cvt_pk_bf16_f32 v118, v124, v125
    v_cvt_pk_bf16_f32 v119, v126, v127
    v_add_u32 v7, 512, v7
    s_add_u32 s88, s88, 8192
    s_and_b32 s88, s88, 0x6000
    s_setprio 3
    v_mfma_f32_32x32x16_bf16 v[144:159], v[48:51], v[112:115], 0
    v_exp_f32 v128, v128
    v_exp_f32 v129, v129
    v_exp_f32 v130, v130
    v_mfma_f32_32x32x16_bf16 v[144:159], v[52:55], v[116:119], v[144:159]
    v_exp_f32 v131, v131
    v_exp_f32 v132, v132
    v_exp_f32 v133, v133
    v_mfma_f32_32x32x16_bf16 v[112:127], v[24:27], v[12:15], 0
    s_setprio 1
    v_cvt_pk_bf16_f32 v128, v128, v129
    v_cvt_pk_bf16_f32 v129, v130, v131
    v_exp_f32 v134, v134
    v_exp_f32 v135, v135
    v_cvt_pk_bf16_f32 v130, v132, v133
    v_exp_f32 v136, v136
    v_exp_f32 v137, v137
    v_cvt_pk_bf16_f32 v131, v134, v135
    v_exp_f32 v138, v138
    v_exp_f32 v139, v139
    v_cvt_pk_bf16_f32 v132, v136, v137
    v_exp_f32 v140, v140
    v_exp_f32 v141, v141
    v_cvt_pk_bf16_f32 v133, v138, v139
    v_exp_f32 v142, v142
    v_exp_f32 v143, v143
    v_cvt_pk_bf16_f32 v134, v140, v141
    v_cvt_pk_bf16_f32 v135, v142, v143
    s_setprio 3
    v_mfma_f32_32x32x16_bf16 v[144:159], v[56:59], v[128:131], v[144:159]
    v_exp_f32 v112, v112
    v_exp_f32 v113, v113
    v_exp_f32 v114, v114
    v_mfma_f32_32x32x16_bf16 v[144:159], v[60:63], v[132:135], v[144:159]
    v_exp_f32 v115, v115
    v_exp_f32 v116, v116
    v_exp_f32 v117, v117
    v_mfma_f32_32x32x16_bf16 v[128:143], v[28:31], v[12:15], 0
    s_setprio 1
    v_cvt_pk_bf16_f32 v112, v112, v113
    v_cvt_pk_bf16_f32 v113, v114, v115
    v_exp_f32 v118, v118
    v_exp_f32 v119, v119
    v_cvt_pk_bf16_f32 v114, v116, v117
    v_exp_f32 v120, v120
    v_exp_f32 v121, v121
    v_cvt_pk_bf16_f32 v115, v118, v119
    v_exp_f32 v122, v122
    v_exp_f32 v123, v123
    v_cvt_pk_bf16_f32 v116, v120, v121
    v_exp_f32 v124, v124
    v_exp_f32 v125, v125
    v_cvt_pk_bf16_f32 v117, v122, v123
    v_exp_f32 v126, v126
    v_exp_f32 v127, v127
    v_cvt_pk_bf16_f32 v118, v124, v125
    v_cvt_pk_bf16_f32 v119, v126, v127
    s_setprio 3
    v_mfma_f32_32x32x16_bf16 v[144:159], v[64:67], v[112:115], v[144:159]
    v_exp_f32 v128, v128
    v_exp_f32 v129, v129
    v_exp_f32 v130, v130
    v_mfma_f32_32x32x16_bf16 v[144:159], v[68:71], v[116:119], v[144:159]
    v_exp_f32 v131, v131
    v_exp_f32 v132, v132
    v_exp_f32 v133, v133
    v_mfma_f32_32x32x16_bf16 v[112:127], v[32:35], v[12:15], 0
    s_setprio 1
    v_cvt_pk_bf16_f32 v128, v128, v129
    v_cvt_pk_bf16_f32 v129, v130, v131
    v_exp_f32 v134, v134
    v_exp_f32 v135, v135
    v_cvt_pk_bf16_f32 v130, v132, v133
    v_exp_f32 v136, v136
    v_exp_f32 v137, v137
    v_cvt_pk_bf16_f32 v131, v134, v135
    v_exp_f32 v138, v138
    v_exp_f32 v139, v139
    v_cvt_pk_bf16_f32 v132, v136, v137
    v_exp_f32 v140, v140
    v_exp_f32 v141, v141
    v_cvt_pk_bf16_f32 v133, v138, v139
    v_exp_f32 v142, v142
    v_exp_f32 v143, v143
    v_cvt_pk_bf16_f32 v134, v140, v141
    v_cvt_pk_bf16_f32 v135, v142, v143
    s_setprio 3
    v_mfma_f32_32x32x16_bf16 v[144:159], v[72:75], v[128:131], v[144:159]
    v_exp_f32 v112, v112
    v_exp_f32 v113, v113
    v_exp_f32 v114, v114
    v_mfma_f32_32x32x16_bf16 v[144:159], v[76:79], v[132:135], v[144:159]
    v_exp_f32 v115, v115
    v_exp_f32 v116, v116
    v_exp_f32 v117, v117
    v_mfma_f32_32x32x16_bf16 v[128:143], v[36:39], v[12:15], 0
    s_setprio 1
    v_cvt_pk_bf16_f32 v112, v112, v113
    v_cvt_pk_bf16_f32 v113, v114, v115
    v_exp_f32 v118, v118
    v_exp_f32 v119, v119
    v_cvt_pk_bf16_f32 v114, v116, v117
    v_exp_f32 v120, v120
    v_exp_f32 v121, v121
    v_cvt_pk_bf16_f32 v115, v118, v119
    v_exp_f32 v122, v122
    v_exp_f32 v123, v123
    v_cvt_pk_bf16_f32 v116, v120, v121
    v_exp_f32 v124, v124
    v_exp_f32 v125, v125
    v_cvt_pk_bf16_f32 v117, v122, v123
    v_exp_f32 v126, v126
    v_exp_f32 v127, v127
    v_cvt_pk_bf16_f32 v118, v124, v125
    v_cvt_pk_bf16_f32 v119, v126, v127
    s_setprio 3
    v_mfma_f32_32x32x16_bf16 v[144:159], v[80:83], v[112:115], v[144:159]
    v_exp_f32 v128, v128
    v_exp_f32 v129, v129
    v_exp_f32 v130, v130
    v_mfma_f32_32x32x16_bf16 v[144:159], v[84:87], v[116:119], v[144:159]
    v_exp_f32 v131, v131
    v_exp_f32 v132, v132
    v_exp_f32 v133, v133
    v_mfma_f32_32x32x16_bf16 v[112:127], v[40:43], v[12:15], 0
    s_setprio 1
    v_cvt_pk_bf16_f32 v128, v128, v129
    v_cvt_pk_bf16_f32 v129, v130, v131
    v_exp_f32 v134, v134
    v_exp_f32 v135, v135
    v_cvt_pk_bf16_f32 v130, v132, v133
    v_exp_f32 v136, v136
    v_exp_f32 v137, v137
    v_cvt_pk_bf16_f32 v131, v134, v135
    v_exp_f32 v138, v138
    v_exp_f32 v139, v139
    v_cvt_pk_bf16_f32 v132, v136, v137
    v_exp_f32 v140, v140
    v_exp_f32 v141, v141
    v_cvt_pk_bf16_f32 v133, v138, v139
    v_exp_f32 v142, v142
    v_exp_f32 v143, v143
    v_cvt_pk_bf16_f32 v134, v140, v141
    v_cvt_pk_bf16_f32 v135, v142, v143
    s_setprio 3
    v_mfma_f32_32x32x16_bf16 v[144:159], v[88:91], v[128:131], v[144:159]
    v_exp_f32 v112, v112
    v_exp_f32 v113, v113
    v_exp_f32 v114, v114
    v_mfma_f32_32x32x16_bf16 v[144:159], v[92:95], v[132:135], v[144:159]
    v_exp_f32 v115, v115
    v_exp_f32 v116, v116
    v_exp_f32 v117, v117
    v_mfma_f32_32x32x16_bf16 v[128:143], v[44:47], v[12:15], 0
    s_setprio 1
    ds_read_b128 v[12:15], v8 offset:1024
    v_cvt_pk_bf16_f32 v112, v112, v113
    v_cvt_pk_bf16_f32 v113, v114, v115
    v_exp_f32 v118, v118
    v_exp_f32 v119, v119
    v_cvt_pk_bf16_f32 v114, v116, v117
    v_exp_f32 v120, v120
    v_exp_f32 v121, v121
    v_cvt_pk_bf16_f32 v115, v118, v119
    v_exp_f32 v122, v122
    v_exp_f32 v123, v123
    v_cvt_pk_bf16_f32 v116, v120, v121
    v_exp_f32 v124, v124
    v_exp_f32 v125, v125
    v_cvt_pk_bf16_f32 v117, v122, v123
    v_exp_f32 v126, v126
    v_exp_f32 v127, v127
    v_cvt_pk_bf16_f32 v118, v124, v125
    v_cvt_pk_bf16_f32 v119, v126, v127
    s_waitcnt lgkmcnt(0)
    s_setprio 3
    v_mfma_f32_32x32x16_bf16 v[144:159], v[96:99], v[112:115], v[144:159]
    v_exp_f32 v128, v128
    v_exp_f32 v129, v129
    v_exp_f32 v130, v130
    v_mfma_f32_32x32x16_bf16 v[144:159], v[100:103], v[116:119], v[144:159]
    v_exp_f32 v131, v131
    v_exp_f32 v132, v132
    v_exp_f32 v133, v133
    v_mfma_f32_32x32x16_bf16 v[112:127], v[16:19], v[12:15], 0
    s_setprio 1
    v_cvt_pk_bf16_f32 v128, v128, v129
    v_cvt_pk_bf16_f32 v129, v130, v131
    v_exp_f32 v134, v134
    v_exp_f32 v135, v135
    v_cvt_pk_bf16_f32 v130, v132, v133
    v_exp_f32 v136, v136
    v_exp_f32 v137, v137
    v_cvt_pk_bf16_f32 v131, v134, v135
    v_exp_f32 v138, v138
    v_exp_f32 v139, v139
    v_cvt_pk_bf16_f32 v132, v136, v137
    v_exp_f32 v140, v140
    v_exp_f32 v141, v141
    v_cvt_pk_bf16_f32 v133, v138, v139
    v_exp_f32 v142, v142
    v_exp_f32 v143, v143
    v_cvt_pk_bf16_f32 v134, v140, v141
    v_cvt_pk_bf16_f32 v135, v142, v143
    v_add_u32 v8, 1024, v8
    s_add_u32 s84, s84, 1
    s_cmp_lt_u32 s84, 6
    s_cbranch_scc1 L_aloopa_31
    s_branch L_aloope_33
.p2align 6
L_aloopb_32:
    s_setprio 3
    v_mfma_f32_32x32x16_bf16 v[144:159], v[104:107], v[128:131], v[144:159]
    v_exp_f32 v112, v112
    v_exp_f32 v113, v113
    v_exp_f32 v114, v114
    v_mfma_f32_32x32x16_bf16 v[144:159], v[108:111], v[132:135], v[144:159]
    v_exp_f32 v115, v115
    v_exp_f32 v116, v116
    v_exp_f32 v117, v117
    v_mfma_f32_32x32x16_bf16 v[128:143], v[20:23], v[12:15], 0
    s_setprio 1
    ds_read_b32 v3, v7 offset:264
    v_cvt_pk_bf16_f32 v112, v112, v113
    v_cvt_pk_bf16_f32 v113, v114, v115
    v_exp_f32 v118, v118
    v_exp_f32 v119, v119
    v_cvt_pk_bf16_f32 v114, v116, v117
    v_add_u32 v4, s88, v9
    v_exp_f32 v120, v120
    v_exp_f32 v121, v121
    v_cvt_pk_bf16_f32 v156, v144, v145
    v_cvt_pk_bf16_f32 v115, v118, v119
    v_cvt_pk_bf16_f32 v157, v146, v147
    v_exp_f32 v122, v122
    v_cvt_pk_bf16_f32 v158, v148, v149
    v_exp_f32 v123, v123
    v_cvt_pk_bf16_f32 v159, v150, v151
    v_cvt_pk_bf16_f32 v116, v120, v121
    s_waitcnt lgkmcnt(0)
    v_readfirstlane_b32 s51, v3
    v_exp_f32 v124, v124
    v_exp_f32 v125, v125
    s_cmp_lt_u32 s84, 4
    s_cselect_b32 s51, 1, s51
    s_cmp_lg_u32 s51, 0
    s_cbranch_scc1 L_sf_35
    s_call_b64 s[86:87], L_wslot
L_sf_35:
    ds_write_b128 v4, v[156:159]
    s_mov_b32 exec_hi, 0
    v_cvt_f64_f32 v[10:11], v152
    s_mov_b32 exec_hi, 1
    ds_add_f64 v7, v[10:11] offset:2048
    s_mov_b32 exec_hi, -1
    v_cvt_pk_bf16_f32 v117, v122, v123
    v_exp_f32 v126, v126
    v_exp_f32 v127, v127
    v_cvt_pk_bf16_f32 v118, v124, v125
    v_cvt_pk_bf16_f32 v119, v126, v127
    v_add_u32 v7, 512, v7
    s_add_u32 s88, s88, 8192
    s_and_b32 s88, s88, 0x6000
    s_setprio 3
    v_mfma_f32_32x32x16_bf16 v[144:159], v[48:51], v[112:115], 0
    v_exp_f32 v128, v128
    v_exp_f32 v129, v129
    v_exp_f32 v130, v130
    v_mfma_f32_32x32x16_bf16 v[144:159], v[52:55], v[116:119], v[144:159]
    v_exp_f32 v131, v131
    v_exp_f32 v132, v132
    v_exp_f32 v133, v133
    v_mfma_f32_32x32x16_bf16 v[112:127], v[24:27], v[12:15], 0
    s_setprio 1
    v_cvt_pk_bf16_f32 v128, v128, v129
    v_cvt_pk_bf16_f32 v129, v130, v131
    v_exp_f32 v134, v134
    v_exp_f32 v135, v135
    v_cvt_pk_bf16_f32 v130, v132, v133
    v_exp_f32 v136, v136
    v_exp_f32 v137, v137
    v_cvt_pk_bf16_f32 v131, v134, v135
    v_exp_f32 v138, v138
    v_exp_f32 v139, v139
    v_cvt_pk_bf16_f32 v132, v136, v137
    v_exp_f32 v140, v140
    v_exp_f32 v141, v141
    v_cvt_pk_bf16_f32 v133, v138, v139
    v_exp_f32 v142, v142
    v_exp_f32 v143, v143
    v_cvt_pk_bf16_f32 v134, v140, v141
    v_cvt_pk_bf16_f32 v135, v142, v143
    s_setprio 3
    v_mfma_f32_32x32x16_bf16 v[144:159], v[56:59], v[128:131], v[144:159]
    v_exp_f32 v112, v112
    v_exp_f32 v113, v113
    v_exp_f32 v114, v114
    v_mfma_f32_32x32x16_bf16 v[144:159], v[60:63], v[132:135], v[144:159]
    v_exp_f32 v115, v115
    v_exp_f32 v116, v116
    v_exp_f32 v117, v117
    v_mfma_f32_32x32x16_bf16 v[128:143], v[28:31], v[12:15], 0
    s_setprio 0
    v_cvt_pk_bf16_f32 v112, v112, v113
    v_cvt_pk_bf16_f32 v113, v114, v115
    v_exp_f32 v118, v118
    v_exp_f32 v119, v119
    v_cvt_pk_bf16_f32 v114, v116, v117
    v_exp_f32 v120, v120
    v_exp_f32 v121, v121
    v_cvt_pk_bf16_f32 v115, v118, v119
    v_exp_f32 v122, v122
    v_exp_f32 v123, v123
    v_cvt_pk_bf16_f32 v116, v120, v121
    v_exp_f32 v124, v124
    v_exp_f32 v125, v125
    v_cvt_pk_bf16_f32 v117, v122, v123
    v_exp_f32 v126, v126
    v_exp_f32 v127, v127
    v_cvt_pk_bf16_f32 v118, v124, v125
    v_cvt_pk_bf16_f32 v119, v126, v127
    s_setprio 3
    v_mfma_f32_32x32x16_bf16 v[144:159], v[64:67], v[112:115], v[144:159]
    v_exp_f32 v128, v128
    v_exp_f32 v129, v129
    v_exp_f32 v130, v130
    v_mfma_f32_32x32x16_bf16 v[144:159], v[68:71], v[116:119], v[144:159]
    v_exp_f32 v131, v131
    v_exp_f32 v132, v132
    v_exp_f32 v133, v133
    v_mfma_f32_32x32x16_bf16 v[112:127], v[32:35], v[12:15], 0
    s_setprio 0
    v_cvt_pk_bf16_f32 v128, v128, v129
    v_cvt_pk_bf16_f32 v129, v130, v131
    v_exp_f32 v134, v134
    v_exp_f32 v135, v135
    v_cvt_pk_bf16_f32 v130, v132, v133
    v_exp_f32 v136, v136
    v_exp_f32 v137, v137
    v_cvt_pk_bf16_f32 v131, v134, v135
    v_exp_f32 v138, v138
    v_exp_f32 v139, v139
    v_cvt_pk_bf16_f32 v132, v136, v137
    v_exp_f32 v140, v140
    v_exp_f32 v141, v141
    v_cvt_pk_bf16_f32 v133, v138, v139
    v_exp_f32 v142, v142
    v_exp_f32 v143, v143
    v_cvt_pk_bf16_f32 v134, v140, v141
    v_cvt_pk_bf16_f32 v135, v142, v143
    s_setprio 3
    v_mfma_f32_32x32x16_bf16 v[144:159], v[72:75], v[128:131], v[144:159]
    v_exp_f32 v112, v112
    v_exp_f32 v113, v113
    v_exp_f32 v114, v114
    v_mfma_f32_32x32x16_bf16 v[144:159], v[76:79], v[132:135], v[144:159]
    v_exp_f32 v115, v115
    v_exp_f32 v116, v116
    v_exp_f32 v117, v117
    v_mfma_f32_32x32x16_bf16 v[128:143], v[36:39], v[12:15], 0
    s_setprio 0
    v_cvt_pk_bf16_f32 v112, v112, v113
    v_cvt_pk_bf16_f32 v113, v114, v115
    v_exp_f32 v118, v118
    v_exp_f32 v119, v119
    v_cvt_pk_bf16_f32 v114, v116, v117
    v_exp_f32 v120, v120
    v_exp_f32 v121, v121
    v_cvt_pk_bf16_f32 v115, v118, v119
    v_exp_f32 v122, v122
    v_exp_f32 v123, v123
    v_cvt_pk_bf16_f32 v116, v120, v121
    v_exp_f32 v124, v124
    v_exp_f32 v125, v125
    v_cvt_pk_bf16_f32 v117, v122, v123
    v_exp_f32 v126, v126
    v_exp_f32 v127, v127
    v_cvt_pk_bf16_f32 v118, v124, v125
    v_cvt_pk_bf16_f32 v119, v126, v127
    s_setprio 3
    v_mfma_f32_32x32x16_bf16 v[144:159], v[80:83], v[112:115], v[144:159]
    v_exp_f32 v128, v128
    v_exp_f32 v129, v129
    v_exp_f32 v130, v130
    v_mfma_f32_32x32x16_bf16 v[144:159], v[84:87], v[116:119], v[144:159]
    v_exp_f32 v131, v131
    v_exp_f32 v132, v132
    v_exp_f32 v133, v133
    v_mfma_f32_32x32x16_bf16 v[112:127], v[40:43], v[12:15], 0
    s_setprio 0
    v_cvt_pk_bf16_f32 v128, v128, v129
    v_cvt_pk_bf16_f32 v129, v130, v131
    v_exp_f32 v134, v134
    v_exp_f32 v135, v135
    v_cvt_pk_bf16_f32 v130, v132, v133
    v_exp_f32 v136, v136
    v_exp_f32 v137, v137
    v_cvt_pk_bf16_f32 v131, v134, v135
    v_exp_f32 v138, v138
    v_exp_f32 v139, v139
    v_cvt_pk_bf16_f32 v132, v136, v137
    v_exp_f32 v140, v140
    v_exp_f32 v141, v141
    v_cvt_pk_bf16_f32 v133, v138, v139
    v_exp_f32 v142, v142
    v_exp_f32 v143, v143
    v_cvt_pk_bf16_f32 v134, v140, v141
    v_cvt_pk_bf16_f32 v135, v142, v143
    s_setprio 3
    v_mfma_f32_32x32x16_bf16 v[144:159], v[88:91], v[128:131], v[144:159]
    v_exp_f32 v112, v112
    v_exp_f32 v113, v113
    v_exp_f32 v114, v114
    v_mfma_f32_32x32x16_bf16 v[144:159], v[92:95], v[132:135], v[144:159]
    v_exp_f32 v115, v115
    v_exp_f32 v116, v116
    v_exp_f32 v117, v117
    v_mfma_f32_32x32x16_bf16 v[128:143], v[44:47], v[12:15], 0
    s_setprio 0
    ds_read_b128 v[12:15], v8 offset:1024
    v_cvt_pk_bf16_f32 v112, v112, v113
    v_cvt_pk_bf16_f32 v113, v114, v115
    v_exp_f32 v118, v118
    v_exp_f32 v119, v119
    v_cvt_pk_bf16_f32 v114, v116, v117
    v_exp_f32 v120, v120
    v_exp_f32 v121, v121
    v_cvt_pk_bf16_f32 v115, v118, v119
    v_exp_f32 v122, v122
    v_exp_f32 v123, v123
    v_cvt_pk_bf16_f32 v116, v120, v121
    v_exp_f32 v124, v124
    v_exp_f32 v125, v125
    v_cvt_pk_bf16_f32 v117, v122, v123
    v_exp_f32 v126, v126
    v_exp_f32 v127, v127
    v_cvt_pk_bf16_f32 v118, v124, v125
    v_cvt_pk_bf16_f32 v119, v126, v127
    s_waitcnt lgkmcnt(0)
    s_setprio 3
    v_mfma_f32_32x32x16_bf16 v[144:159], v[96:99], v[112:115], v[144:159]
    v_exp_f32 v128, v128
    v_exp_f32 v129, v129
    v_exp_f32 v130, v130
    v_mfma_f32_32x32x16_bf16 v[144:159], v[100:103], v[116:119], v[144:159]
    v_exp_f32 v131, v131
    v_exp_f32 v132, v132
    v_exp_f32 v133, v133
    v_mfma_f32_32x32x16_bf16 v[112:127], v[16:19], v[12:15], 0
    s_setprio 0
    v_cvt_pk_bf16_f32 v128, v128, v129
    v_cvt_pk_bf16_f32 v129, v130, v131
    v_exp_f32 v134, v134
    v_exp_f32 v135, v135
    v_cvt_pk_bf16_f32 v130, v132, v133
    v_exp_f32 v136, v136
    v_exp_f32 v137, v137
    v_cvt_pk_bf16_f32 v131, v134, v135
    v_exp_f32 v138, v138
    v_exp_f32 v139, v139
    v_cvt_pk_bf16_f32 v132, v136, v137
    v_exp_f32 v140, v140
    v_exp_f32 v141, v141
    v_cvt_pk_bf16_f32 v133, v138, v139
    v_exp_f32 v142, v142
    v_exp_f32 v143, v143
    v_cvt_pk_bf16_f32 v134, v140, v141
    v_cvt_pk_bf16_f32 v135, v142, v143
    v_add_u32 v8, 1024, v8
    s_add_u32 s84, s84, 1
    s_cmp_lt_u32 s84, 6
    s_cbranch_scc1 L_aloopb_32
L_aloope_33:
    s_setprio 0
    v_mfma_f32_32x32x16_bf16 v[144:159], v[104:107], v[128:131], v[144:159]
    v_exp_f32 v112, v112
    v_exp_f32 v113, v113
    v_exp_f32 v114, v114
    v_mfma_f32_32x32x16_bf16 v[144:159], v[108:111], v[132:135], v[144:159]
    v_exp_f32 v115, v115
    v_exp_f32 v116, v116
    v_exp_f32 v117, v117
    v_mfma_f32_32x32x16_bf16 v[128:143], v[20:23], v[12:15], 0
    s_nop 0
    ds_read_b32 v3, v7 offset:264
    v_cvt_pk_bf16_f32 v112, v112, v113
    v_cvt_pk_bf16_f32 v113, v114, v115
    v_exp_f32 v118, v118
    v_exp_f32 v119, v119
    v_cvt_pk_bf16_f32 v114, v116, v117
    v_add_u32 v4, s88, v9
    v_exp_f32 v120, v120
    v_exp_f32 v121, v121
    v_cvt_pk_bf16_f32 v156, v144, v145
    v_cvt_pk_bf16_f32 v115, v118, v119
    v_cvt_pk_bf16_f32 v157, v146, v147
    v_exp_f32 v122, v122
    v_cvt_pk_bf16_f32 v158, v148, v149
    v_exp_f32 v123, v123
    v_cvt_pk_bf16_f32 v159, v150, v151
    v_cvt_pk_bf16_f32 v116, v120, v121
    s_waitcnt lgkmcnt(0)
    v_readfirstlane_b32 s51, v3
    v_exp_f32 v124, v124
    v_exp_f32 v125, v125
    s_cmp_lt_u32 s84, 4
    s_cselect_b32 s51, 1, s51
    s_cmp_lg_u32 s51, 0
    s_cbranch_scc1 L_sf_36
    s_call_b64 s[86:87], L_wslot
L_sf_36:
    ds_write_b128 v4, v[156:159]
    s_mov_b32 exec_hi, 0
    v_cvt_f64_f32 v[10:11], v152
    s_mov_b32 exec_hi, 1
    ds_add_f64 v7, v[10:11] offset:2048
    s_mov_b32 exec_hi, -1
    v_cvt_pk_bf16_f32 v117, v122, v123
    v_exp_f32 v126, v126
    v_exp_f32 v127, v127
    v_cvt_pk_bf16_f32 v118, v124, v125
    v_cvt_pk_bf16_f32 v119, v126, v127
    v_add_u32 v7, 512, v7
    s_add_u32 s88, s88, 8192
    s_and_b32 s88, s88, 0x6000
    v_mfma_f32_32x32x16_bf16 v[144:159], v[48:51], v[112:115], 0
    v_exp_f32 v128, v128
    v_exp_f32 v129, v129
    v_exp_f32 v130, v130
    v_mfma_f32_32x32x16_bf16 v[144:159], v[52:55], v[116:119], v[144:159]
    v_exp_f32 v131, v131
    v_exp_f32 v132, v132
    v_exp_f32 v133, v133
    v_mfma_f32_32x32x16_bf16 v[112:127], v[24:27], v[12:15], 0
    v_cvt_pk_bf16_f32 v128, v128, v129
    v_cvt_pk_bf16_f32 v129, v130, v131
    v_exp_f32 v134, v134
    v_exp_f32 v135, v135
    v_cvt_pk_bf16_f32 v130, v132, v133
    v_exp_f32 v136, v136
    v_exp_f32 v137, v137
    v_cvt_pk_bf16_f32 v131, v134, v135
    v_exp_f32 v138, v138
    v_exp_f32 v139, v139
    v_cvt_pk_bf16_f32 v132, v136, v137
    v_exp_f32 v140, v140
    v_exp_f32 v141, v141
    v_cvt_pk_bf16_f32 v133, v138, v139
    v_exp_f32 v142, v142
    v_exp_f32 v143, v143
    v_cvt_pk_bf16_f32 v134, v140, v141
    v_cvt_pk_bf16_f32 v135, v142, v143
    v_mfma_f32_32x32x16_bf16 v[144:159], v[56:59], v[128:131], v[144:159]
    v_exp_f32 v112, v112
    v_exp_f32 v113, v113
    v_exp_f32 v114, v114
    v_mfma_f32_32x32x16_bf16 v[144:159], v[60:63], v[132:135], v[144:159]
    v_exp_f32 v115, v115
    v_exp_f32 v116, v116
    v_exp_f32 v117, v117
    v_mfma_f32_32x32x16_bf16 v[128:143], v[28:31], v[12:15], 0
    v_cvt_pk_bf16_f32 v112, v112, v113
    v_cvt_pk_bf16_f32 v113, v114, v115
    v_exp_f32 v118, v118
    v_exp_f32 v119, v119
    v_cvt_pk_bf16_f32 v114, v116, v117
    v_exp_f32 v120, v120
    v_exp_f32 v121, v121
    v_cvt_pk_bf16_f32 v115, v118, v119
    v_exp_f32 v122, v122
    v_exp_f32 v123, v123
    v_cvt_pk_bf16_f32 v116, v120, v121
    v_exp_f32 v124, v124
    v_exp_f32 v125, v125
    v_cvt_pk_bf16_f32 v117, v122, v123
    v_exp_f32 v126, v126
    v_exp_f32 v127, v127
    v_cvt_pk_bf16_f32 v118, v124, v125
    v_cvt_pk_bf16_f32 v119, v126, v127
    v_mfma_f32_32x32x16_bf16 v[144:159], v[64:67], v[112:115], v[144:159]
    v_exp_f32 v128, v128
    v_exp_f32 v129, v129
    v_exp_f32 v130, v130
    v_mfma_f32_32x32x16_bf16 v[144:159], v[68:71], v[116:119], v[144:159]
    v_exp_f32 v131, v131
    v_exp_f32 v132, v132
    v_exp_f32 v133, v133
    v_mfma_f32_32x32x16_bf16 v[112:127], v[32:35], v[12:15], 0
    v_cvt_pk_bf16_f32 v128, v128, v129
    v_cvt_pk_bf16_f32 v129, v130, v131
    v_exp_f32 v134, v134
    v_exp_f32 v135, v135
    v_cvt_pk_bf16_f32 v130, v132, v133
    v_exp_f32 v136, v136
    v_exp_f32 v137, v137
    v_cvt_pk_bf16_f32 v131, v134, v135
    v_exp_f32 v138, v138
    v_exp_f32 v139, v139
    v_cvt_pk_bf16_f32 v132, v136, v137
    v_exp_f32 v140, v140
    v_exp_f32 v141, v141
    v_cvt_pk_bf16_f32 v133, v138, v139
    v_exp_f32 v142, v142
    v_exp_f32 v143, v143
    v_cvt_pk_bf16_f32 v134, v140, v141
    v_cvt_pk_bf16_f32 v135, v142, v143
    v_mfma_f32_32x32x16_bf16 v[144:159], v[72:75], v[128:131], v[144:159]
    v_exp_f32 v112, v112
    v_exp_f32 v113, v113
    v_exp_f32 v114, v114
    v_mfma_f32_32x32x16_bf16 v[144:159], v[76:79], v[132:135], v[144:159]
    v_exp_f32 v115, v115
    v_exp_f32 v116, v116
    v_exp_f32 v117, v117
    v_mfma_f32_32x32x16_bf16 v[128:143], v[36:39], v[12:15], 0
    v_cvt_pk_bf16_f32 v112, v112, v113
    v_cvt_pk_bf16_f32 v113, v114, v115
    v_exp_f32 v118, v118
    v_exp_f32 v119, v119
    v_cvt_pk_bf16_f32 v114, v116, v117
    v_exp_f32 v120, v120
    v_exp_f32 v121, v121
    v_cvt_pk_bf16_f32 v115, v118, v119
    v_exp_f32 v122, v122
    v_exp_f32 v123, v123
    v_cvt_pk_bf16_f32 v116, v120, v121
    v_exp_f32 v124, v124
    v_exp_f32 v125, v125
    v_cvt_pk_bf16_f32 v117, v122, v123
    v_exp_f32 v126, v126
    v_exp_f32 v127, v127
    v_cvt_pk_bf16_f32 v118, v124, v125
    v_cvt_pk_bf16_f32 v119, v126, v127
    v_mfma_f32_32x32x16_bf16 v[144:159], v[80:83], v[112:115], v[144:159]
    v_exp_f32 v128, v128
    v_exp_f32 v129, v129
    v_exp_f32 v130, v130
    v_mfma_f32_32x32x16_bf16 v[144:159], v[84:87], v[116:119], v[144:159]
    v_exp_f32 v131, v131
    v_exp_f32 v132, v132
    v_exp_f32 v133, v133
    v_mfma_f32_32x32x16_bf16 v[112:127], v[40:43], v[12:15], 0
    v_cvt_pk_bf16_f32 v128, v128, v129
    v_cvt_pk_bf16_f32 v129, v130, v131
    v_exp_f32 v134, v134
    v_exp_f32 v135, v135
    v_cvt_pk_bf16_f32 v130, v132, v133
    v_exp_f32 v136, v136
    v_exp_f32 v137, v137
    v_cvt_pk_bf16_f32 v131, v134, v135
    v_exp_f32 v138, v138
    v_exp_f32 v139, v139
    v_cvt_pk_bf16_f32 v132, v136, v137
    v_exp_f32 v140, v140
    v_exp_f32 v141, v141
    v_cvt_pk_bf16_f32 v133, v138, v139
    v_exp_f32 v142, v142
    v_exp_f32 v143, v143
    v_cvt_pk_bf16_f32 v134, v140, v141
    v_cvt_pk_bf16_f32 v135, v142, v143
    v_mfma_f32_32x32x16_bf16 v[144:159], v[88:91], v[128:131], v[144:159]
    v_exp_f32 v112, v112
    v_exp_f32 v113, v113
    v_exp_f32 v114, v114
    v_mfma_f32_32x32x16_bf16 v[144:159], v[92:95], v[132:135], v[144:159]
    v_exp_f32 v115, v115
    v_exp_f32 v116, v116
    v_exp_f32 v117, v117
    v_mfma_f32_32x32x16_bf16 v[128:143], v[44:47], v[12:15], 0
    v_cvt_pk_bf16_f32 v112, v112, v113
    v_cvt_pk_bf16_f32 v113, v114, v115
    v_exp_f32 v118, v118
    v_exp_f32 v119, v119
    v_cvt_pk_bf16_f32 v114, v116, v117
    v_exp_f32 v120, v120
    v_exp_f32 v121, v121
    v_cvt_pk_bf16_f32 v115, v118, v119
    v_exp_f32 v122, v122
    v_exp_f32 v123, v123
    v_cvt_pk_bf16_f32 v116, v120, v121
    v_exp_f32 v124, v124
    v_exp_f32 v125, v125
    v_cvt_pk_bf16_f32 v117, v122, v123
    v_exp_f32 v126, v126
    v_exp_f32 v127, v127
    v_cvt_pk_bf16_f32 v118, v124, v125
    v_cvt_pk_bf16_f32 v119, v126, v127
    v_mfma_f32_32x32x16_bf16 v[144:159], v[96:99], v[112:115], v[144:159]
    v_exp_f32 v128, v128
    v_exp_f32 v129, v129
    v_exp_f32 v130, v130
    v_mfma_f32_32x32x16_bf16 v[144:159], v[100:103], v[116:119], v[144:159]
    v_exp_f32 v131, v131
    v_exp_f32 v132, v132
    v_exp_f32 v133, v133
    v_cvt_pk_bf16_f32 v128, v128, v129
    v_cvt_pk_bf16_f32 v129, v130, v131
    v_exp_f32 v134, v134
    v_exp_f32 v135, v135
    v_cvt_pk_bf16_f32 v130, v132, v133
    v_exp_f32 v136, v136
    v_exp_f32 v137, v137
    v_cvt_pk_bf16_f32 v131, v134, v135
    v_exp_f32 v138, v138
    v_exp_f32 v139, v139
    v_cvt_pk_bf16_f32 v132, v136, v137
    v_exp_f32 v140, v140
    v_exp_f32 v141, v141
    v_cvt_pk_bf16_f32 v133, v138, v139
    v_exp_f32 v142, v142
    v_exp_f32 v143, v143
    v_cvt_pk_bf16_f32 v134, v140, v141
    v_cvt_pk_bf16_f32 v135, v142, v143
    s_add_u32 s84, s84, 1
    s_setprio 3
    v_mfma_f32_32x32x16_bf16 v[144:159], v[104:107], v[128:131], v[144:159]
    v_mfma_f32_32x32x16_bf16 v[144:159], v[108:111], v[132:135], v[144:159]
    s_nop 11
    ds_read_b32 v3, v7 offset:264
    v_cvt_pk_bf16_f32 v156, v144, v145
    v_cvt_pk_bf16_f32 v157, v146, v147
    v_cvt_pk_bf16_f32 v158, v148, v149
    v_cvt_pk_bf16_f32 v159, v150, v151
    v_add_u32 v4, s88, v9
    s_waitcnt lgkmcnt(0)
    v_readfirstlane_b32 s51, v3
    s_nop 0
    s_cmp_lt_u32 s84, 4
    s_cselect_b32 s51, 1, s51
    s_cmp_lg_u32 s51, 0
    s_cbranch_scc1 L_sf_37
    s_call_b64 s[86:87], L_wslot
L_sf_37:
    ds_write_b128 v4, v[156:159]
    s_mov_b32 exec_hi, 0
    v_cvt_f64_f32 v[10:11], v152
    s_mov_b32 exec_hi, 1
    ds_add_rtn_f64 v[4:5], v7, v[10:11] offset:2048
    s_mov_b32 exec_hi, -1
    v_add_u32 v3, 141312, v2
    v_and_b32 v12, 31, v1
    v_lshlrev_b32 v12, 3, v12
    v_add_u32 v12, 153088, v12
    ds_read_b64 v[12:13], v12
    ds_read_b128 v[112:115], v3 offset:0
    ds_read_b128 v[116:119], v3 offset:1024
    ds_read_b128 v[120:123], v3 offset:2048
    ds_read_b128 v[124:127], v3 offset:3072
    ds_read_b128 v[128:131], v3 offset:4096
    ds_read_b128 v[132:135], v3 offset:5120
    ds_read_b128 v[136:139], v3 offset:6144
    ds_read_b128 v[140:143], v3 offset:7168
    v_add_u32 v7, 512, v7
    s_add_u32 s88, s88, 8192
    s_and_b32 s88, s88, 0x6000
    s_waitcnt lgkmcnt(9)
    v_readlane_b32 s51, v5, 32
    s_nop 0
    s_cmp_lg_u32 s51, s85
    s_cbranch_scc1 L_nl_38
    s_cmp_lg_u32 s84, 7
    s_cbranch_scc1 L_nl_38
    s_call_b64 s[86:87], L_pub
L_nl_38:
    s_waitcnt lgkmcnt(0)
    s_add_u32 s84, s84, 1
    s_mov_b32 s3, 2097152
L_lw_39:
    ds_read_b32 v3, v6 offset:76
    s_sub_u32 s3, s3, 1
    s_waitcnt lgkmcnt(0)
    v_cmp_gt_u32 vcc, 8, v3
    s_cbranch_vccz L_lwd_40
    s_sleep 1
    s_cbranch_scc0 L_lw_39
L_lwd_40:
    ds_read_b32 v3, v6 offset:12
    s_waitcnt lgkmcnt(0)
    v_cmp_ne_u32 vcc, 0, v3
    s_cbranch_vccnz L_slow
L_aend:
    s_endpgm
L_pub:
    s_waitcnt lgkmcnt(7)
    v_mfma_f32_32x32x16_bf16 v[144:159], v[160:163], v[112:115], 0
    s_waitcnt lgkmcnt(6)
    v_mfma_f32_32x32x16_bf16 v[144:159], v[160:163], v[116:119], v[144:159]
    s_waitcnt lgkmcnt(5)
    v_mfma_f32_32x32x16_bf16 v[144:159], v[160:163], v[120:123], v[144:159]
    s_waitcnt lgkmcnt(4)
    v_mfma_f32_32x32x16_bf16 v[144:159], v[160:163], v[124:127], v[144:159]
    s_waitcnt lgkmcnt(3)
    v_mfma_f32_32x32x16_bf16 v[144:159], v[160:163], v[128:131], v[144:159]
    s_waitcnt lgkmcnt(2)
    v_mfma_f32_32x32x16_bf16 v[144:159], v[160:163], v[132:135], v[144:159]
    s_waitcnt lgkmcnt(1)
    v_mfma_f32_32x32x16_bf16 v[144:159], v[160:163], v[136:139], v[144:159]
    s_waitcnt lgkmcnt(0)
    v_mfma_f32_32x32x16_bf16 v[144:159], v[160:163], v[140:143], v[144:159]
    s_lshl_b32 s51, s49, 3
    s_and_b32 s52, s84, 1
    s_lshl_b32 s52, s52, 2
    s_add_u32 s51, s51, s52
    s_lshr_b32 s52, s84, 1
    s_add_u32 s51, s51, s52
    s_lshl_b32 s51, s51, 3
    s_add_u32 s51, s51, s50
    s_lshl_b32 s52, s51, 10
    s_add_u32 s52, s52, 8388608
    v_cvt_f32_f64 v12, v[12:13]
    v_rcp_f32 v12, v12
    s_nop 0
    v_pk_mul_f32 v[144:145], v[144:145], v[12:13] op_sel_hi:[1,0]
    v_pk_mul_f32 v[146:147], v[146:147], v[12:13] op_sel_hi:[1,0]
    v_pk_mul_f32 v[148:149], v[148:149], v[12:13] op_sel_hi:[1,0]
    v_pk_mul_f32 v[150:151], v[150:151], v[12:13] op_sel_hi:[1,0]
    v_cvt_pk_bf16_f32 v144, v144, v145
    v_cvt_pk_bf16_f32 v145, v146, v147
    v_cvt_pk_bf16_f32 v146, v148, v149
    v_cvt_pk_bf16_f32 v147, v150, v151
    v_min_u32 v144, -2, v144
    v_min_u32 v145, -2, v145
    v_min_u32 v146, -2, v146
    v_min_u32 v147, -2, v147
    s_cmp_lt_u32 s84, 6
    s_cbranch_scc1 L_nf_41
    s_add_u32 s51, s52, 2097152
    buffer_store_dwordx4 v[144:147], v2, s[32:35], s51 offen
L_nf_41:
    buffer_store_dwordx4 v[144:147], v2, s[32:35], s52 offen sc1
    s_setpc_b64 s[86:87]
L_wslot:
    s_mov_b32 s3, 2097152
L_wslot1:
    s_sleep 2
    ds_read_b32 v3, v7 offset:264
    ds_read_b32 v5, v6 offset:92
    s_waitcnt lgkmcnt(0)
    v_or_b32 v3, v3, v5
    s_nop 0
    v_readfirstlane_b32 s51, v3
    s_nop 0
    s_cmp_lg_u32 s51, 0
    s_cbranch_scc1 L_wslot2
    s_sub_u32 s3, s3, 1
    s_cbranch_scc0 L_wslot1
L_wslot2:
    s_setpc_b64 s[86:87]
L_g1:
    s_mov_b32 s36, s16
    s_mov_b32 s37, s17
    s_mov_b32 s38, 0x1c0000
    s_mov_b32 s39, 0x20000
    s_mov_b32 s88, s56
    v_and_b32 v3, 1, v1
    v_lshlrev_b32 v3, 4, v3
    v_mov_b32 v4, 0x3f80
    v_lshlrev_b32 v4, v3, v4
    v_lshrrev_b32 v3, 3, v1
    v_and_b32 v3, 4, v3
    v_xor_b32 v3, v3, v1
    v_and_b32 v3, 0x1e, v3
    v_cmp_eq_u32 vcc, 0, v3
    s_nop 1
    v_cndmask_b32 v144, 0, v4, vcc
    v_cmp_eq_u32 vcc, 2, v3
    s_nop 1
    v_cndmask_b32 v145, 0, v4, vcc
    v_cmp_eq_u32 vcc, 8, v3
    s_nop 1
    v_cndmask_b32 v146, 0, v4, vcc
    v_cmp_eq_u32 vcc, 10, v3
    s_nop 1
    v_cndmask_b32 v147, 0, v4, vcc
    s_mov_b32 s3, 2097152
L_lw_42:
    ds_read_b32 v3, v6 offset:48
    s_sub_u32 s3, s3, 1
    s_waitcnt lgkmcnt(0)
    v_cmp_gt_u32 vcc, 8, v3
    s_cbranch_vccz L_lwd_43
    s_sleep 4
    s_cbranch_scc0 L_lw_42
L_lwd_43:
    ds_read_b64 v[80:81], v6 offset:64
    s_waitcnt lgkmcnt(0)
    v_readfirstlane_b32 s58, v80
    v_readfirstlane_b32 s59, v81
    s_mov_b32 s44, s18
    s_mov_b32 s45, s19
    s_mov_b32 s46, 0x1c0000
    s_mov_b32 s47, 0x20000
    s_mov_b32 s8, s12
    s_mov_b32 s9, s13
    s_mov_b32 s10, 0x80000
    s_mov_b32 s11, 0x20000
    v_lshlrev_b32 v112, 7, v1
    s_lshr_b32 s51, s2, 3
    s_mul_i32 s54, s51, 57344
    s_lshl_b32 s52, s56, 14
    s_add_u32 s54, s54, s52
    s_lshl_b32 s89, s51, 14
    s_lshl_b32 s52, s56, 12
    s_add_u32 s89, s89, s52
    s_mov_b32 s85, 0
    s_lshl_b32 s84, s50, 2
    s_add_u32 s84, s84, s56
    s_mul_i32 s86, s56, 458752
    s_lshl_b32 s51, s50, 7
    s_add_u32 s86, s86, s51
    s_cmp_eq_u32 s50, 7
    s_cbranch_scc1 L_g1skip_44
    s_add_u32 m0, s90, 0
    s_lshl_b32 s91, s84, 7
    buffer_load_dwordx4 v9, s[36:39], s91 offen lds
    buffer_load_dwordx4 v10, s[36:39], s91 offen offset:1024 lds
    s_add_u32 m0, s90, 2048
    s_add_u32 s91, s91, 57344
    buffer_load_dwordx4 v9, s[36:39], s91 offen lds
    buffer_load_dwordx4 v10, s[36:39], s91 offen offset:1024 lds
    s_add_u32 m0, s90, 4096
    s_add_u32 s91, s91, 57344
    buffer_load_dwordx4 v9, s[36:39], s91 offen lds
    buffer_load_dwordx4 v10, s[36:39], s91 offen offset:1024 lds
    s_add_u32 m0, s90, 6144
    s_add_u32 s91, s91, 57344
    buffer_load_dwordx4 v9, s[36:39], s91 offen lds
    buffer_load_dwordx4 v10, s[36:39], s91 offen offset:1024 lds
    s_add_u32 m0, s90, 8192
    s_add_u32 s91, s91, 57344
    buffer_load_dwordx4 v9, s[36:39], s91 offen lds
    buffer_load_dwordx4 v10, s[36:39], s91 offen offset:1024 lds
    s_add_u32 m0, s90, 10240
    s_add_u32 s91, s91, 57344
    buffer_load_dwordx4 v9, s[36:39], s91 offen lds
    buffer_load_dwordx4 v10, s[36:39], s91 offen offset:1024 lds
    v_lshl_add_u32 v12, v15, 10, v11
    v_add_u32 v12, s90, v12
    v_xor_b32 v13, 64, v12
    v_add_u32 v0, 33792, v14
    s_setprio 1
    s_waitcnt vmcnt(10)
    ds_read_b64_tr_b16 v[80:81], v12 offset:0
    ds_read_b64_tr_b16 v[82:83], v12 offset:512
    ds_read_b64_tr_b16 v[84:85], v13 offset:0
    ds_read_b64_tr_b16 v[86:87], v13 offset:512
    ds_read_b128 v[96:99], v14 offset:0
    ds_read_b128 v[100:103], v0 offset:0
    s_waitcnt lgkmcnt(0)
    v_mfma_f32_32x32x16_bf16 v[16:31], v[80:83], v[96:99], 0
    ds_read_b128 v[104:107], v14 offset:1056
    ds_read_b128 v[108:111], v0 offset:1056
    s_waitcnt vmcnt(8)
    ds_read_b64_tr_b16 v[88:89], v12 offset:2048
    ds_read_b64_tr_b16 v[90:91], v12 offset:2560
    v_mfma_f32_32x32x16_bf16 v[32:47], v[80:83], v[100:103], 0
    ds_read_b64_tr_b16 v[92:93], v13 offset:2048
    ds_read_b64_tr_b16 v[94:95], v13 offset:2560
    v_mfma_f32_32x32x16_bf16 v[64:79], v[84:87], v[100:103], 0
    s_add_u32 m0, s90, 0
    s_add_u32 s91, s91, 57344
    buffer_load_dwordx4 v9, s[36:39], s91 offen lds
    v_mfma_f32_32x32x16_bf16 v[48:63], v[84:87], v[96:99], 0
    buffer_load_dwordx4 v10, s[36:39], s91 offen offset:1024 lds
    s_waitcnt lgkmcnt(0)
    v_mfma_f32_32x32x16_bf16 v[16:31], v[88:91], v[104:107], v[16:31]
    ds_read_b128 v[96:99], v14 offset:2112
    ds_read_b128 v[100:103], v0 offset:2112
    s_waitcnt vmcnt(8)
    ds_read_b64_tr_b16 v[80:81], v12 offset:4096
    ds_read_b64_tr_b16 v[82:83], v12 offset:4608
    v_mfma_f32_32x32x16_bf16 v[32:47], v[88:91], v[108:111], v[32:47]
    ds_read_b64_tr_b16 v[84:85], v13 offset:4096
    ds_read_b64_tr_b16 v[86:87], v13 offset:4608
    v_mfma_f32_32x32x16_bf16 v[64:79], v[92:95], v[108:111], v[64:79]
    s_add_u32 m0, s90, 2048
    s_add_u32 s91, s91, 57344
    buffer_load_dwordx4 v9, s[36:39], s91 offen lds
    v_mfma_f32_32x32x16_bf16 v[48:63], v[92:95], v[104:107], v[48:63]
    buffer_load_dwordx4 v10, s[36:39], s91 offen offset:1024 lds
    s_waitcnt lgkmcnt(0)
    v_mfma_f32_32x32x16_bf16 v[16:31], v[80:83], v[96:99], v[16:31]
    ds_read_b128 v[104:107], v14 offset:3168
    ds_read_b128 v[108:111], v0 offset:3168
    s_waitcnt vmcnt(8)
    ds_read_b64_tr_b16 v[88:89], v12 offset:6144
    ds_read_b64_tr_b16 v[90:91], v12 offset:6656
    v_mfma_f32_32x32x16_bf16 v[32:47], v[80:83], v[100:103], v[32:47]
    ds_read_b64_tr_b16 v[92:93], v13 offset:6144
    ds_read_b64_tr_b16 v[94:95], v13 offset:6656
    v_mfma_f32_32x32x16_bf16 v[64:79], v[84:87], v[100:103], v[64:79]
    s_add_u32 m0, s90, 4096
    s_add_u32 s91, s91, 57344
    buffer_load_dwordx4 v9, s[36:39], s91 offen lds
    v_mfma_f32_32x32x16_bf16 v[48:63], v[84:87], v[96:99], v[48:63]
    buffer_load_dwordx4 v10, s[36:39], s91 offen offset:1024 lds
    s_waitcnt lgkmcnt(0)
    v_mfma_f32_32x32x16_bf16 v[16:31], v[88:91], v[104:107], v[16:31]
    ds_read_b128 v[96:99], v14 offset:4224
    ds_read_b128 v[100:103], v0 offset:4224
    s_waitcnt vmcnt(8)
    ds_read_b64_tr_b16 v[80:81], v12 offset:8192
    ds_read_b64_tr_b16 v[82:83], v12 offset:8704
    v_mfma_f32_32x32x16_bf16 v[32:47], v[88:91], v[108:111], v[32:47]
    ds_read_b64_tr_b16 v[84:85], v13 offset:8192
    ds_read_b64_tr_b16 v[86:87], v13 offset:8704
    v_mfma_f32_32x32x16_bf16 v[64:79], v[92:95], v[108:111], v[64:79]
    s_add_u32 m0, s90, 6144
    s_add_u32 s91, s91, 57344
    buffer_load_dwordx4 v9, s[36:39], s91 offen lds
    v_mfma_f32_32x32x16_bf16 v[48:63], v[92:95], v[104:107], v[48:63]
    buffer_load_dwordx4 v10, s[36:39], s91 offen offset:1024 lds
    s_waitcnt lgkmcnt(0)
    v_mfma_f32_32x32x16_bf16 v[16:31], v[80:83], v[96:99], v[16:31]
    ds_read_b128 v[104:107], v14 offset:5280
    ds_read_b128 v[108:111], v0 offset:5280
    s_waitcnt vmcnt(8)
    ds_read_b64_tr_b16 v[88:89], v12 offset:10240
    ds_read_b64_tr_b16 v[90:91], v12 offset:10752
    v_mfma_f32_32x32x16_bf16 v[32:47], v[80:83], v[100:103], v[32:47]
    ds_read_b64_tr_b16 v[92:93], v13 offset:10240
    ds_read_b64_tr_b16 v[94:95], v13 offset:10752
    v_mfma_f32_32x32x16_bf16 v[64:79], v[84:87], v[100:103], v[64:79]
    s_add_u32 m0, s90, 8192
    s_add_u32 s91, s91, 57344
    buffer_load_dwordx4 v9, s[36:39], s91 offen lds
    v_mfma_f32_32x32x16_bf16 v[48:63], v[84:87], v[96:99], v[48:63]
    buffer_load_dwordx4 v10, s[36:39], s91 offen offset:1024 lds
    buffer_load_dword v113, v112, s[44:47], s54 offen sc1
    s_add_u32 s54, s54, 8192
    s_waitcnt lgkmcnt(0)
    v_mfma_f32_32x32x16_bf16 v[16:31], v[88:91], v[104:107], v[16:31]
    ds_read_b128 v[96:99], v14 offset:6336
    ds_read_b128 v[100:103], v0 offset:6336
    s_waitcnt vmcnt(9)
    ds_read_b64_tr_b16 v[80:81], v12 offset:0
    ds_read_b64_tr_b16 v[82:83], v12 offset:512
    v_mfma_f32_32x32x16_bf16 v[32:47], v[88:91], v[108:111], v[32:47]
    ds_read_b64_tr_b16 v[84:85], v13 offset:0
    ds_read_b64_tr_b16 v[86:87], v13 offset:512
    v_mfma_f32_32x32x16_bf16 v[64:79], v[92:95], v[108:111], v[64:79]
    s_add_u32 m0, s90, 10240
    s_add_u32 s91, s91, 57344
    buffer_load_dwordx4 v9, s[36:39], s91 offen lds
    v_mfma_f32_32x32x16_bf16 v[48:63], v[92:95], v[104:107], v[48:63]
    buffer_load_dwordx4 v10, s[36:39], s91 offen offset:1024 lds
    s_waitcnt lgkmcnt(0)
    v_mfma_f32_32x32x16_bf16 v[16:31], v[80:83], v[96:99], v[16:31]
    ds_read_b128 v[104:107], v14 offset:7392
    ds_read_b128 v[108:111], v0 offset:7392
    s_waitcnt vmcnt(9)
    ds_read_b64_tr_b16 v[88:89], v12 offset:2048
    ds_read_b64_tr_b16 v[90:91], v12 offset:2560
    v_mfma_f32_32x32x16_bf16 v[32:47], v[80:83], v[100:103], v[32:47]
    ds_read_b64_tr_b16 v[92:93], v13 offset:2048
    ds_read_b64_tr_b16 v[94:95], v13 offset:2560
    v_mfma_f32_32x32x16_bf16 v[64:79], v[84:87], v[100:103], v[64:79]
    s_add_u32 m0, s90, 0
    s_add_u32 s91, s91, 57344
    buffer_load_dwordx4 v9, s[36:39], s91 offen lds
    v_mfma_f32_32x32x16_bf16 v[48:63], v[84:87], v[96:99], v[48:63]
    buffer_load_dwordx4 v10, s[36:39], s91 offen offset:1024 lds
    s_waitcnt lgkmcnt(0)
    v_mfma_f32_32x32x16_bf16 v[16:31], v[88:91], v[104:107], v[16:31]
    ds_read_b128 v[96:99], v14 offset:8448
    ds_read_b128 v[100:103], v0 offset:8448
    s_waitcnt vmcnt(9)
    ds_read_b64_tr_b16 v[80:81], v12 offset:4096
    ds_read_b64_tr_b16 v[82:83], v12 offset:4608
    v_mfma_f32_32x32x16_bf16 v[32:47], v[88:91], v[108:111], v[32:47]
    ds_read_b64_tr_b16 v[84:85], v13 offset:4096
    ds_read_b64_tr_b16 v[86:87], v13 offset:4608
    v_mfma_f32_32x32x16_bf16 v[64:79], v[92:95], v[108:111], v[64:79]
    s_add_u32 m0, s90, 2048
    s_add_u32 s91, s91, 57344
    buffer_load_dwordx4 v9, s[36:39], s91 offen lds
    v_mfma_f32_32x32x16_bf16 v[48:63], v[92:95], v[104:107], v[48:63]
    buffer_load_dwordx4 v10, s[36:39], s91 offen offset:1024 lds
    s_waitcnt lgkmcnt(0)
    v_mfma_f32_32x32x16_bf16 v[16:31], v[80:83], v[96:99], v[16:31]
    ds_read_b128 v[104:107], v14 offset:9504
    ds_read_b128 v[108:111], v0 offset:9504
    s_waitcnt vmcnt(9)
    ds_read_b64_tr_b16 v[88:89], v12 offset:6144
    ds_read_b64_tr_b16 v[90:91], v12 offset:6656
    v_mfma_f32_32x32x16_bf16 v[32:47], v[80:83], v[100:103], v[32:47]
    ds_read_b64_tr_b16 v[92:93], v13 offset:6144
    ds_read_b64_tr_b16 v[94:95], v13 offset:6656
    v_mfma_f32_32x32x16_bf16 v[64:79], v[84:87], v[100:103], v[64:79]
    s_add_u32 m0, s90, 4096
    s_add_u32 s91, s91, 57344
    buffer_load_dwordx4 v9, s[36:39], s91 offen lds
    v_mfma_f32_32x32x16_bf16 v[48:63], v[84:87], v[96:99], v[48:63]
    buffer_load_dwordx4 v10, s[36:39], s91 offen offset:1024 lds
    s_waitcnt lgkmcnt(0)
    v_mfma_f32_32x32x16_bf16 v[16:31], v[88:91], v[104:107], v[16:31]
    ds_read_b128 v[96:99], v14 offset:10560
    ds_read_b128 v[100:103], v0 offset:10560
    s_waitcnt vmcnt(9)
    ds_read_b64_tr_b16 v[80:81], v12 offset:8192
    ds_read_b64_tr_b16 v[82:83], v12 offset:8704
    v_mfma_f32_32x32x16_bf16 v[32:47], v[88:91], v[108:111], v[32:47]
    ds_read_b64_tr_b16 v[84:85], v13 offset:8192
    ds_read_b64_tr_b16 v[86:87], v13 offset:8704
    v_mfma_f32_32x32x16_bf16 v[64:79], v[92:95], v[108:111], v[64:79]
    s_add_u32 m0, s90, 6144
    s_add_u32 s91, s91, 57344
    buffer_load_dwordx4 v9, s[36:39], s91 offen lds
    v_mfma_f32_32x32x16_bf16 v[48:63], v[92:95], v[104:107], v[48:63]
    buffer_load_dwordx4 v10, s[36:39], s91 offen offset:1024 lds
    s_waitcnt lgkmcnt(0)
    v_mfma_f32_32x32x16_bf16 v[16:31], v[80:83], v[96:99], v[16:31]
    ds_read_b128 v[104:107], v14 offset:11616
    ds_read_b128 v[108:111], v0 offset:11616
    s_waitcnt vmcnt(8)
    ds_read_b64_tr_b16 v[88:89], v12 offset:10240
    ds_read_b64_tr_b16 v[90:91], v12 offset:10752
    v_mfma_f32_32x32x16_bf16 v[32:47], v[80:83], v[100:103], v[32:47]
    ds_read_b64_tr_b16 v[92:93], v13 offset:10240
    ds_read_b64_tr_b16 v[94:95], v13 offset:10752
    v_mfma_f32_32x32x16_bf16 v[64:79], v[84:87], v[100:103], v[64:79]
    s_add_u32 m0, s90, 8192
    s_add_u32 s91, s91, 57344
    buffer_load_dwordx4 v9, s[36:39], s91 offen lds
    v_mfma_f32_32x32x16_bf16 v[48:63], v[84:87], v[96:99], v[48:63]
    buffer_load_dwordx4 v10, s[36:39], s91 offen offset:1024 lds
    s_waitcnt lgkmcnt(0)
    v_mfma_f32_32x32x16_bf16 v[16:31], v[88:91], v[104:107], v[16:31]
    ds_read_b128 v[96:99], v14 offset:12672
    ds_read_b128 v[100:103], v0 offset:12672
    s_waitcnt vmcnt(8)
    ds_read_b64_tr_b16 v[80:81], v12 offset:0
    ds_read_b64_tr_b16 v[82:83], v12 offset:512
    v_mfma_f32_32x32x16_bf16 v[32:47], v[88:91], v[108:111], v[32:47]
    ds_read_b64_tr_b16 v[84:85], v13 offset:0
    ds_read_b64_tr_b16 v[86:87], v13 offset:512
    v_mfma_f32_32x32x16_bf16 v[64:79], v[92:95], v[108:111], v[64:79]
    s_add_u32 m0, s90, 10240
    s_add_u32 s91, s91, 57344
    buffer_load_dwordx4 v9, s[36:39], s91 offen lds
    v_mfma_f32_32x32x16_bf16 v[48:63], v[92:95], v[104:107], v[48:63]
    buffer_load_dwordx4 v10, s[36:39], s91 offen offset:1024 lds
    buffer_load_dword v113, v112, s[44:47], s54 offen sc1
    s_add_u32 s54, s54, 8192
    s_waitcnt lgkmcnt(0)
    v_mfma_f32_32x32x16_bf16 v[16:31], v[80:83], v[96:99], v[16:31]
    ds_read_b128 v[104:107], v14 offset:13728
    ds_read_b128 v[108:111], v0 offset:13728
    s_waitcnt vmcnt(9)
    ds_read_b64_tr_b16 v[88:89], v12 offset:2048
    ds_read_b64_tr_b16 v[90:91], v12 offset:2560
    v_mfma_f32_32x32x16_bf16 v[32:47], v[80:83], v[100:103], v[32:47]
    ds_read_b64_tr_b16 v[92:93], v13 offset:2048
    ds_read_b64_tr_b16 v[94:95], v13 offset:2560
    v_mfma_f32_32x32x16_bf16 v[64:79], v[84:87], v[100:103], v[64:79]
    s_add_u32 m0, s90, 0
    s_add_u32 s91, s91, 57344
    buffer_load_dwordx4 v9, s[36:39], s91 offen lds
    v_mfma_f32_32x32x16_bf16 v[48:63], v[84:87], v[96:99], v[48:63]
    buffer_load_dwordx4 v10, s[36:39], s91 offen offset:1024 lds
    s_waitcnt lgkmcnt(0)
    v_mfma_f32_32x32x16_bf16 v[16:31], v[88:91], v[104:107], v[16:31]
    ds_read_b128 v[96:99], v14 offset:14784
    ds_read_b128 v[100:103], v0 offset:14784
    s_waitcnt vmcnt(9)
    ds_read_b64_tr_b16 v[80:81], v12 offset:4096
    ds_read_b64_tr_b16 v[82:83], v12 offset:4608
    v_mfma_f32_32x32x16_bf16 v[32:47], v[88:91], v[108:111], v[32:47]
    ds_read_b64_tr_b16 v[84:85], v13 offset:4096
    ds_read_b64_tr_b16 v[86:87], v13 offset:4608
    v_mfma_f32_32x32x16_bf16 v[64:79], v[92:95], v[108:111], v[64:79]
    s_add_u32 m0, s90, 2048
    s_add_u32 s91, s91, 57344
    buffer_load_dwordx4 v9, s[36:39], s91 offen lds
    v_mfma_f32_32x32x16_bf16 v[48:63], v[92:95], v[104:107], v[48:63]
    buffer_load_dwordx4 v10, s[36:39], s91 offen offset:1024 lds
    s_waitcnt lgkmcnt(0)
    v_mfma_f32_32x32x16_bf16 v[16:31], v[80:83], v[96:99], v[16:31]
    ds_read_b128 v[104:107], v14 offset:15840
    ds_read_b128 v[108:111], v0 offset:15840
    s_waitcnt vmcnt(9)
    ds_read_b64_tr_b16 v[88:89], v12 offset:6144
    ds_read_b64_tr_b16 v[90:91], v12 offset:6656
    v_mfma_f32_32x32x16_bf16 v[32:47], v[80:83], v[100:103], v[32:47]
    ds_read_b64_tr_b16 v[92:93], v13 offset:6144
    ds_read_b64_tr_b16 v[94:95], v13 offset:6656
    v_mfma_f32_32x32x16_bf16 v[64:79], v[84:87], v[100:103], v[64:79]
    s_add_u32 m0, s90, 4096
    s_add_u32 s91, s91, 57344
    buffer_load_dwordx4 v9, s[36:39], s91 offen lds
    v_mfma_f32_32x32x16_bf16 v[48:63], v[84:87], v[96:99], v[48:63]
    buffer_load_dwordx4 v10, s[36:39], s91 offen offset:1024 lds
    s_waitcnt lgkmcnt(0)
    v_mfma_f32_32x32x16_bf16 v[16:31], v[88:91], v[104:107], v[16:31]
    ds_read_b128 v[96:99], v14 offset:16896
    ds_read_b128 v[100:103], v0 offset:16896
    s_waitcnt vmcnt(9)
    ds_read_b64_tr_b16 v[80:81], v12 offset:8192
    ds_read_b64_tr_b16 v[82:83], v12 offset:8704
    v_mfma_f32_32x32x16_bf16 v[32:47], v[88:91], v[108:111], v[32:47]
    ds_read_b64_tr_b16 v[84:85], v13 offset:8192
    ds_read_b64_tr_b16 v[86:87], v13 offset:8704
    v_mfma_f32_32x32x16_bf16 v[64:79], v[92:95], v[108:111], v[64:79]
    s_add_u32 m0, s90, 6144
    s_add_u32 s91, s91, 57344
    buffer_load_dwordx4 v9, s[36:39], s91 offen lds
    v_mfma_f32_32x32x16_bf16 v[48:63], v[92:95], v[104:107], v[48:63]
    buffer_load_dwordx4 v10, s[36:39], s91 offen offset:1024 lds
    s_waitcnt lgkmcnt(0)
    v_mfma_f32_32x32x16_bf16 v[16:31], v[80:83], v[96:99], v[16:31]
    ds_read_b128 v[104:107], v14 offset:17952
    ds_read_b128 v[108:111], v0 offset:17952
    s_waitcnt vmcnt(9)
    ds_read_b64_tr_b16 v[88:89], v12 offset:10240
    ds_read_b64_tr_b16 v[90:91], v12 offset:10752
    v_mfma_f32_32x32x16_bf16 v[32:47], v[80:83], v[100:103], v[32:47]
    ds_read_b64_tr_b16 v[92:93], v13 offset:10240
    ds_read_b64_tr_b16 v[94:95], v13 offset:10752
    v_mfma_f32_32x32x16_bf16 v[64:79], v[84:87], v[100:103], v[64:79]
    s_add_u32 m0, s90, 8192
    s_add_u32 s91, s91, 57344
    buffer_load_dwordx4 v9, s[36:39], s91 offen lds
    v_mfma_f32_32x32x16_bf16 v[48:63], v[84:87], v[96:99], v[48:63]
    buffer_load_dwordx4 v10, s[36:39], s91 offen offset:1024 lds
    s_waitcnt lgkmcnt(0)
    v_mfma_f32_32x32x16_bf16 v[16:31], v[88:91], v[104:107], v[16:31]
    ds_read_b128 v[96:99], v14 offset:19008
    ds_read_b128 v[100:103], v0 offset:19008
    s_waitcnt vmcnt(8)
    ds_read_b64_tr_b16 v[80:81], v12 offset:0
    ds_read_b64_tr_b16 v[82:83], v12 offset:512
    v_mfma_f32_32x32x16_bf16 v[32:47], v[88:91], v[108:111], v[32:47]
    ds_read_b64_tr_b16 v[84:85], v13 offset:0
    ds_read_b64_tr_b16 v[86:87], v13 offset:512
    v_mfma_f32_32x32x16_bf16 v[64:79], v[92:95], v[108:111], v[64:79]
    s_add_u32 m0, s90, 10240
    s_add_u32 s91, s91, 57344
    buffer_load_dwordx4 v9, s[36:39], s91 offen lds
    v_mfma_f32_32x32x16_bf16 v[48:63], v[92:95], v[104:107], v[48:63]
    buffer_load_dwordx4 v10, s[36:39], s91 offen offset:1024 lds
    s_waitcnt lgkmcnt(0)
    v_mfma_f32_32x32x16_bf16 v[16:31], v[80:83], v[96:99], v[16:31]
    ds_read_b128 v[104:107], v14 offset:20064
    ds_read_b128 v[108:111], v0 offset:20064
    s_waitcnt vmcnt(8)
    ds_read_b64_tr_b16 v[88:89], v12 offset:2048
    ds_read_b64_tr_b16 v[90:91], v12 offset:2560
    v_mfma_f32_32x32x16_bf16 v[32:47], v[80:83], v[100:103], v[32:47]
    ds_read_b64_tr_b16 v[92:93], v13 offset:2048
    ds_read_b64_tr_b16 v[94:95], v13 offset:2560
    v_mfma_f32_32x32x16_bf16 v[64:79], v[84:87], v[100:103], v[64:79]
    s_add_u32 m0, s90, 0
    s_add_u32 s91, s91, 57344
    buffer_load_dwordx4 v9, s[36:39], s91 offen lds
    v_mfma_f32_32x32x16_bf16 v[48:63], v[84:87], v[96:99], v[48:63]
    buffer_load_dwordx4 v10, s[36:39], s91 offen offset:1024 lds
    s_mov_b32 exec_hi, 0
    buffer_load_dword v113, v112, s[8:11], s89 offen sc1
    s_mov_b64 exec, -1
    s_waitcnt lgkmcnt(0)
    v_mfma_f32_32x32x16_bf16 v[16:31], v[88:91], v[104:107], v[16:31]
    ds_read_b128 v[96:99], v14 offset:21120
    ds_read_b128 v[100:103], v0 offset:21120
    s_waitcnt vmcnt(9)
    ds_read_b64_tr_b16 v[80:81], v12 offset:4096
    ds_read_b64_tr_b16 v[82:83], v12 offset:4608
    v_mfma_f32_32x32x16_bf16 v[32:47], v[88:91], v[108:111], v[32:47]
    ds_read_b64_tr_b16 v[84:85], v13 offset:4096
    ds_read_b64_tr_b16 v[86:87], v13 offset:4608
    v_mfma_f32_32x32x16_bf16 v[64:79], v[92:95], v[108:111], v[64:79]
    s_add_u32 m0, s90, 2048
    s_add_u32 s91, s91, 57344
    buffer_load_dwordx4 v9, s[36:39], s91 offen lds
    v_mfma_f32_32x32x16_bf16 v[48:63], v[92:95], v[104:107], v[48:63]
    buffer_load_dwordx4 v10, s[36:39], s91 offen offset:1024 lds
    s_waitcnt lgkmcnt(0)
    v_mfma_f32_32x32x16_bf16 v[16:31], v[80:83], v[96:99], v[16:31]
    ds_read_b128 v[104:107], v14 offset:22176
    ds_read_b128 v[108:111], v0 offset:22176
    s_waitcnt vmcnt(9)
    ds_read_b64_tr_b16 v[88:89], v12 offset:6144
    ds_read_b64_tr_b16 v[90:91], v12 offset:6656
    v_mfma_f32_32x32x16_bf16 v[32:47], v[80:83], v[100:103], v[32:47]
    ds_read_b64_tr_b16 v[92:93], v13 offset:6144
    ds_read_b64_tr_b16 v[94:95], v13 offset:6656
    v_mfma_f32_32x32x16_bf16 v[64:79], v[84:87], v[100:103], v[64:79]
    s_add_u32 m0, s90, 4096
    s_add_u32 s91, s91, 57344
    buffer_load_dwordx4 v9, s[36:39], s91 offen lds
    v_mfma_f32_32x32x16_bf16 v[48:63], v[84:87], v[96:99], v[48:63]
    buffer_load_dwordx4 v10, s[36:39], s91 offen offset:1024 lds
    s_waitcnt lgkmcnt(0)
    v_mfma_f32_32x32x16_bf16 v[16:31], v[88:91], v[104:107], v[16:31]
    ds_read_b128 v[96:99], v14 offset:23232
    ds_read_b128 v[100:103], v0 offset:23232
    s_waitcnt vmcnt(9)
    ds_read_b64_tr_b16 v[80:81], v12 offset:8192
    ds_read_b64_tr_b16 v[82:83], v12 offset:8704
    v_mfma_f32_32x32x16_bf16 v[32:47], v[88:91], v[108:111], v[32:47]
    ds_read_b64_tr_b16 v[84:85], v13 offset:8192
    ds_read_b64_tr_b16 v[86:87], v13 offset:8704
    v_mfma_f32_32x32x16_bf16 v[64:79], v[92:95], v[108:111], v[64:79]
    s_add_u32 m0, s90, 6144
    s_add_u32 s91, s91, 57344
    buffer_load_dwordx4 v9, s[36:39], s91 offen lds
    v_mfma_f32_32x32x16_bf16 v[48:63], v[92:95], v[104:107], v[48:63]
    buffer_load_dwordx4 v10, s[36:39], s91 offen offset:1024 lds
    s_waitcnt lgkmcnt(0)
    v_mfma_f32_32x32x16_bf16 v[16:31], v[80:83], v[96:99], v[16:31]
    ds_read_b128 v[104:107], v14 offset:24288
    ds_read_b128 v[108:111], v0 offset:24288
    s_waitcnt vmcnt(9)
    ds_read_b64_tr_b16 v[88:89], v12 offset:10240
    ds_read_b64_tr_b16 v[90:91], v12 offset:10752
    v_mfma_f32_32x32x16_bf16 v[32:47], v[80:83], v[100:103], v[32:47]
    ds_read_b64_tr_b16 v[92:93], v13 offset:10240
    ds_read_b64_tr_b16 v[94:95], v13 offset:10752
    v_mfma_f32_32x32x16_bf16 v[64:79], v[84:87], v[100:103], v[64:79]
    s_add_u32 m0, s90, 8192
    s_add_u32 s91, s91, 57344
    buffer_load_dwordx4 v9, s[36:39], s91 offen lds
    v_mfma_f32_32x32x16_bf16 v[48:63], v[84:87], v[96:99], v[48:63]
    buffer_load_dwordx4 v10, s[36:39], s91 offen offset:1024 lds
    s_waitcnt lgkmcnt(0)
    v_mfma_f32_32x32x16_bf16 v[16:31], v[88:91], v[104:107], v[16:31]
    ds_read_b128 v[96:99], v14 offset:25344
    ds_read_b128 v[100:103], v0 offset:25344
    s_waitcnt vmcnt(9)
    ds_read_b64_tr_b16 v[80:81], v12 offset:0
    ds_read_b64_tr_b16 v[82:83], v12 offset:512
    v_mfma_f32_32x32x16_bf16 v[32:47], v[88:91], v[108:111], v[32:47]
    ds_read_b64_tr_b16 v[84:85], v13 offset:0
    ds_read_b64_tr_b16 v[86:87], v13 offset:512
    v_mfma_f32_32x32x16_bf16 v[64:79], v[92:95], v[108:111], v[64:79]
    s_add_u32 m0, s90, 10240
    s_add_u32 s91, s91, 57344
    buffer_load_dwordx4 v9, s[36:39], s91 offen lds
    v_mfma_f32_32x32x16_bf16 v[48:63], v[92:95], v[104:107], v[48:63]
    buffer_load_dwordx4 v10, s[36:39], s91 offen offset:1024 lds
    s_waitcnt lgkmcnt(0)
    v_mfma_f32_32x32x16_bf16 v[16:31], v[80:83], v[96:99], v[16:31]
    ds_read_b128 v[104:107], v14 offset:26400
    ds_read_b128 v[108:111], v0 offset:26400
    s_waitcnt vmcnt(8)
    ds_read_b64_tr_b16 v[88:89], v12 offset:2048
    ds_read_b64_tr_b16 v[90:91], v12 offset:2560
    v_mfma_f32_32x32x16_bf16 v[32:47], v[80:83], v[100:103], v[32:47]
    ds_read_b64_tr_b16 v[92:93], v13 offset:2048
    ds_read_b64_tr_b16 v[94:95], v13 offset:2560
    v_mfma_f32_32x32x16_bf16 v[64:79], v[84:87], v[100:103], v[64:79]
    s_add_u32 m0, s90, 0
    s_add_u32 s91, s91, 57344
    buffer_load_dwordx4 v9, s[36:39], s91 offen lds
    v_mfma_f32_32x32x16_bf16 v[48:63], v[84:87], v[96:99], v[48:63]
    buffer_load_dwordx4 v10, s[36:39], s91 offen offset:1024 lds
    s_waitcnt lgkmcnt(0)
    v_mfma_f32_32x32x16_bf16 v[16:31], v[88:91], v[104:107], v[16:31]
    ds_read_b128 v[96:99], v14 offset:27456
    ds_read_b128 v[100:103], v0 offset:27456
    s_waitcnt vmcnt(8)
    ds_read_b64_tr_b16 v[80:81], v12 offset:4096
    ds_read_b64_tr_b16 v[82:83], v12 offset:4608
    v_mfma_f32_32x32x16_bf16 v[32:47], v[88:91], v[108:111], v[32:47]
    ds_read_b64_tr_b16 v[84:85], v13 offset:4096
    ds_read_b64_tr_b16 v[86:87], v13 offset:4608
    v_mfma_f32_32x32x16_bf16 v[64:79], v[92:95], v[108:111], v[64:79]
    s_add_u32 m0, s90, 2048
    s_add_u32 s91, s91, 57344
    buffer_load_dwordx4 v9, s[36:39], s91 offen lds
    v_mfma_f32_32x32x16_bf16 v[48:63], v[92:95], v[104:107], v[48:63]
    buffer_load_dwordx4 v10, s[36:39], s91 offen offset:1024 lds
    s_waitcnt lgkmcnt(0)
    v_mfma_f32_32x32x16_bf16 v[16:31], v[80:83], v[96:99], v[16:31]
    ds_read_b128 v[104:107], v14 offset:28512
    ds_read_b128 v[108:111], v0 offset:28512
    s_waitcnt vmcnt(8)
    ds_read_b64_tr_b16 v[88:89], v12 offset:6144
    ds_read_b64_tr_b16 v[90:91], v12 offset:6656
    v_mfma_f32_32x32x16_bf16 v[32:47], v[80:83], v[100:103], v[32:47]
    ds_read_b64_tr_b16 v[92:93], v13 offset:6144
    ds_read_b64_tr_b16 v[94:95], v13 offset:6656
    v_mfma_f32_32x32x16_bf16 v[64:79], v[84:87], v[100:103], v[64:79]
    s_add_u32 m0, s90, 4096
    s_add_u32 s87, s85, 0
    s_and_b32 s87, s87, 3
    s_mul_i32 s87, s87, 114688
    s_add_u32 s91, s87, s86
    buffer_load_dwordx4 v7, s[44:47], s91 offen lds
    v_mfma_f32_32x32x16_bf16 v[48:63], v[84:87], v[96:99], v[48:63]
    buffer_load_dwordx4 v8, s[44:47], s91 offen offset:1024 lds
    s_waitcnt lgkmcnt(0)
    v_mfma_f32_32x32x16_bf16 v[16:31], v[88:91], v[104:107], v[16:31]
    ds_read_b128 v[96:99], v14 offset:29568
    ds_read_b128 v[100:103], v0 offset:29568
    s_waitcnt vmcnt(8)
    ds_read_b64_tr_b16 v[80:81], v12 offset:8192
    ds_read_b64_tr_b16 v[82:83], v12 offset:8704
    v_mfma_f32_32x32x16_bf16 v[32:47], v[88:91], v[108:111], v[32:47]
    ds_read_b64_tr_b16 v[84:85], v13 offset:8192
    ds_read_b64_tr_b16 v[86:87], v13 offset:8704
    v_mfma_f32_32x32x16_bf16 v[64:79], v[92:95], v[108:111], v[64:79]
    s_add_u32 m0, s90, 6144
    s_add_u32 s91, s91, 16384
    buffer_load_dwordx4 v7, s[44:47], s91 offen lds
    v_mfma_f32_32x32x16_bf16 v[48:63], v[92:95], v[104:107], v[48:63]
    buffer_load_dwordx4 v8, s[44:47], s91 offen offset:1024 lds
    s_waitcnt lgkmcnt(0)
    v_mfma_f32_32x32x16_bf16 v[16:31], v[80:83], v[96:99], v[16:31]
    ds_read_b128 v[104:107], v14 offset:30624
    ds_read_b128 v[108:111], v0 offset:30624
    s_waitcnt vmcnt(8)
    ds_read_b64_tr_b16 v[88:89], v12 offset:10240
    ds_read_b64_tr_b16 v[90:91], v12 offset:10752
    v_mfma_f32_32x32x16_bf16 v[32:47], v[80:83], v[100:103], v[32:47]
    ds_read_b64_tr_b16 v[92:93], v13 offset:10240
    ds_read_b64_tr_b16 v[94:95], v13 offset:10752
    v_mfma_f32_32x32x16_bf16 v[64:79], v[84:87], v[100:103], v[64:79]
    s_add_u32 m0, s90, 8192
    s_add_u32 s91, s91, 16384
    buffer_load_dwordx4 v7, s[44:47], s91 offen lds
    v_mfma_f32_32x32x16_bf16 v[48:63], v[84:87], v[96:99], v[48:63]
    buffer_load_dwordx4 v8, s[44:47], s91 offen offset:1024 lds
    s_waitcnt lgkmcnt(0)
    v_mfma_f32_32x32x16_bf16 v[16:31], v[88:91], v[104:107], v[16:31]
    ds_read_b128 v[96:99], v14 offset:31680
    ds_read_b128 v[100:103], v0 offset:31680
    s_waitcnt vmcnt(8)
    ds_read_b64_tr_b16 v[80:81], v12 offset:0
    ds_read_b64_tr_b16 v[82:83], v12 offset:512
    v_mfma_f32_32x32x16_bf16 v[32:47], v[88:91], v[108:111], v[32:47]
    ds_read_b64_tr_b16 v[84:85], v13 offset:0
    ds_read_b64_tr_b16 v[86:87], v13 offset:512
    v_mfma_f32_32x32x16_bf16 v[64:79], v[92:95], v[108:111], v[64:79]
    s_add_u32 m0, s90, 10240
    s_add_u32 s91, s91, 16384
    buffer_load_dwordx4 v7, s[44:47], s91 offen lds
    v_mfma_f32_32x32x16_bf16 v[48:63], v[92:95], v[104:107], v[48:63]
    buffer_load_dwordx4 v8, s[44:47], s91 offen offset:1024 lds
    s_waitcnt lgkmcnt(0)
    v_mfma_f32_32x32x16_bf16 v[16:31], v[80:83], v[96:99], v[16:31]
    ds_read_b128 v[104:107], v14 offset:32736
    ds_read_b128 v[108:111], v0 offset:32736
    s_waitcnt vmcnt(8)
    ds_read_b64_tr_b16 v[88:89], v12 offset:2048
    ds_read_b64_tr_b16 v[90:91], v12 offset:2560
    v_mfma_f32_32x32x16_bf16 v[32:47], v[80:83], v[100:103], v[32:47]
    ds_read_b64_tr_b16 v[92:93], v13 offset:2048
    ds_read_b64_tr_b16 v[94:95], v13 offset:2560
    v_mfma_f32_32x32x16_bf16 v[64:79], v[84:87], v[100:103], v[64:79]
    s_add_u32 m0, s90, 0
    s_add_u32 s91, s91, 16384
    buffer_load_dwordx4 v7, s[44:47], s91 offen lds
    v_mfma_f32_32x32x16_bf16 v[48:63], v[84:87], v[96:99], v[48:63]
    buffer_load_dwordx4 v8, s[44:47], s91 offen offset:1024 lds
    s_waitcnt lgkmcnt(0)
    v_mfma_f32_32x32x16_bf16 v[16:31], v[88:91], v[104:107], v[16:31]
    v_mfma_f32_32x32x16_bf16 v[32:47], v[88:91], v[108:111], v[32:47]
    v_mfma_f32_32x32x16_bf16 v[64:79], v[92:95], v[108:111], v[64:79]
    s_add_u32 m0, s90, 2048
    s_add_u32 s91, s91, 16384
    buffer_load_dwordx4 v7, s[44:47], s91 offen lds
    v_mfma_f32_32x32x16_bf16 v[48:63], v[92:95], v[104:107], v[48:63]
    buffer_load_dwordx4 v8, s[44:47], s91 offen offset:1024 lds
    s_setprio 2
    s_mul_i32 s51, s49, 229376
    s_lshl_b32 s52, s84, 12
    s_add_u32 s51, s51, s52
    s_add_u32 s51, s51, 1048576
    s_add_u32 s52, s51, 114688
    s_nop 6
    v_cvt_pk_bf16_f32 v16, v16, v17
    v_cvt_pk_bf16_f32 v17, v18, v19
    v_cvt_pk_bf16_f32 v18, v20, v21
    v_cvt_pk_bf16_f32 v19, v22, v23
    v_cvt_pk_bf16_f32 v20, v24, v25
    v_cvt_pk_bf16_f32 v21, v26, v27
    v_cvt_pk_bf16_f32 v22, v28, v29
    v_cvt_pk_bf16_f32 v23, v30, v31
    v_pk_max_i16 v16, v16, 0
    v_pk_max_i16 v17, v17, 0
    v_pk_max_i16 v18, v18, 0
    v_pk_max_i16 v19, v19, 0
    v_pk_max_i16 v20, v20, 0
    v_pk_max_i16 v21, v21, 0
    v_pk_max_i16 v22, v22, 0
    v_pk_max_i16 v23, v23, 0
    buffer_store_dwordx4 v[16:19], v2, s[32:35], s51 offen offset:0 sc1
    buffer_store_dwordx4 v[20:23], v2, s[32:35], s51 offen offset:1024 sc1
    v_cvt_pk_bf16_f32 v32, v32, v33
    v_cvt_pk_bf16_f32 v33, v34, v35
    v_cvt_pk_bf16_f32 v34, v36, v37
    v_cvt_pk_bf16_f32 v35, v38, v39
    v_cvt_pk_bf16_f32 v36, v40, v41
    v_cvt_pk_bf16_f32 v37, v42, v43
    v_cvt_pk_bf16_f32 v38, v44, v45
    v_cvt_pk_bf16_f32 v39, v46, v47
    v_pk_max_i16 v32, v32, 0
    v_pk_max_i16 v33, v33, 0
    v_pk_max_i16 v34, v34, 0
    v_pk_max_i16 v35, v35, 0
    v_pk_max_i16 v36, v36, 0
    v_pk_max_i16 v37, v37, 0
    v_pk_max_i16 v38, v38, 0
    v_pk_max_i16 v39, v39, 0
    buffer_store_dwordx4 v[32:35], v2, s[32:35], s52 offen offset:0 sc1
    buffer_store_dwordx4 v[36:39], v2, s[32:35], s52 offen offset:1024 sc1
    v_cvt_pk_bf16_f32 v64, v64, v65
    v_cvt_pk_bf16_f32 v65, v66, v67
    v_cvt_pk_bf16_f32 v66, v68, v69
    v_cvt_pk_bf16_f32 v67, v70, v71
    v_cvt_pk_bf16_f32 v68, v72, v73
    v_cvt_pk_bf16_f32 v69, v74, v75
    v_cvt_pk_bf16_f32 v70, v76, v77
    v_cvt_pk_bf16_f32 v71, v78, v79
    v_pk_max_i16 v64, v64, 0
    v_pk_max_i16 v65, v65, 0
    v_pk_max_i16 v66, v66, 0
    v_pk_max_i16 v67, v67, 0
    v_pk_max_i16 v68, v68, 0
    v_pk_max_i16 v69, v69, 0
    v_pk_max_i16 v70, v70, 0
    v_pk_max_i16 v71, v71, 0
    buffer_store_dwordx4 v[64:67], v2, s[32:35], s52 offen offset:2048 sc1
    buffer_store_dwordx4 v[68:71], v2, s[32:35], s52 offen offset:3072 sc1
    v_cvt_pk_bf16_f32 v48, v48, v49
    v_cvt_pk_bf16_f32 v49, v50, v51
    v_cvt_pk_bf16_f32 v50, v52, v53
    v_cvt_pk_bf16_f32 v51, v54, v55
    v_cvt_pk_bf16_f32 v52, v56, v57
    v_cvt_pk_bf16_f32 v53, v58, v59
    v_cvt_pk_bf16_f32 v54, v60, v61
    v_cvt_pk_bf16_f32 v55, v62, v63
    v_pk_max_i16 v48, v48, 0
    v_pk_max_i16 v49, v49, 0
    v_pk_max_i16 v50, v50, 0
    v_pk_max_i16 v51, v51, 0
    v_pk_max_i16 v52, v52, 0
    v_pk_max_i16 v53, v53, 0
    v_pk_max_i16 v54, v54, 0
    v_pk_max_i16 v55, v55, 0
    buffer_store_dwordx4 v[48:51], v2, s[32:35], s51 offen offset:2048 sc1
    buffer_store_dwordx4 v[52:55], v2, s[32:35], s51 offen offset:3072 sc1
    s_branch L_g1d_45
L_g1skip_44:
    buffer_load_dword v113, v112, s[44:47], s54 offen sc1
    s_add_u32 s54, s54, 8192
    buffer_load_dword v113, v112, s[44:47], s54 offen sc1
    s_add_u32 s54, s54, 8192
    s_mov_b32 exec_hi, 0
    buffer_load_dword v113, v112, s[8:11], s89 offen sc1
    s_mov_b64 exec, -1
    s_add_u32 m0, s90, 4096
    s_add_u32 s87, s85, 0
    s_and_b32 s87, s87, 3
    s_mul_i32 s87, s87, 114688
    s_add_u32 s91, s87, s86
    buffer_load_dwordx4 v7, s[44:47], s91 offen lds
    buffer_load_dwordx4 v8, s[44:47], s91 offen offset:1024 lds
    s_add_u32 m0, s90, 6144
    s_add_u32 s91, s91, 16384
    buffer_load_dwordx4 v7, s[44:47], s91 offen lds
    buffer_load_dwordx4 v8, s[44:47], s91 offen offset:1024 lds
    s_add_u32 m0, s90, 8192
    s_add_u32 s91, s91, 16384
    buffer_load_dwordx4 v7, s[44:47], s91 offen lds
    buffer_load_dwordx4 v8, s[44:47], s91 offen offset:1024 lds
    s_add_u32 m0, s90, 10240
    s_add_u32 s91, s91, 16384
    buffer_load_dwordx4 v7, s[44:47], s91 offen lds
    buffer_load_dwordx4 v8, s[44:47], s91 offen offset:1024 lds
    s_add_u32 m0, s90, 0
    s_add_u32 s91, s91, 16384
    buffer_load_dwordx4 v7, s[44:47], s91 offen lds
    buffer_load_dwordx4 v8, s[44:47], s91 offen offset:1024 lds
    s_add_u32 m0, s90, 2048
    s_add_u32 s91, s91, 16384
    buffer_load_dwordx4 v7, s[44:47], s91 offen lds
    buffer_load_dwordx4 v8, s[44:47], s91 offen offset:1024 lds
L_g1d_45:
    s_lshl_b32 s51, s49, 5
    s_add_u32 s51, s51, s84
    s_lshl_b32 s51, s51, 7
    s_add_u32 s51, s51, 262144
    v_mov_b32 v80, s58
    v_mov_b32 v81, s59
    v_mov_b32 v82, 0
    s_waitcnt vmcnt(0)
    s_mov_b64 exec, 1
    buffer_store_dwordx2 v[80:81], v82, s[32:35], s51 offen sc1
    s_mov_b64 exec, -1
    s_waitcnt lgkmcnt(0)
    v_mov_b32 v3, 1
    s_mov_b64 exec, 1
    ds_add_u32 v6, v3 offset:20
    s_mov_b64 exec, -1
    s_call_b64 s[94:95], L_ftry
    s_mov_b32 s3, 2097152
L_lw_46:
    ds_read_b32 v3, v6 offset:20
    s_sub_u32 s3, s3, 1
    s_waitcnt lgkmcnt(0)
    v_cmp_gt_u32 vcc, 4, v3
    s_cbranch_vccz L_lwd_47
    s_sleep 2
    s_cbranch_scc0 L_lw_46
L_lwd_47:
    s_mul_i32 s92, s56, 131072
    s_lshl_b32 s51, s50, 7
    s_add_u32 s92, s92, s51
    s_mul_i32 s51, s56, 16384
    s_add_u32 m0, s51, 0
    s_nop 0
    buffer_load_dwordx4 v7, s[8:11], s92 offen lds
    buffer_load_dwordx4 v8, s[8:11], s92 offen offset:1024 lds
    s_add_u32 m0, s51, 2048
    s_add_u32 s92, s92, 16384
    buffer_load_dwordx4 v7, s[8:11], s92 offen lds
    buffer_load_dwordx4 v8, s[8:11], s92 offen offset:1024 lds
    s_add_u32 m0, s51, 4096
    s_add_u32 s92, s92, 16384
    buffer_load_dwordx4 v7, s[8:11], s92 offen lds
    buffer_load_dwordx4 v8, s[8:11], s92 offen offset:1024 lds
    s_add_u32 m0, s51, 6144
    s_add_u32 s92, s92, 16384
    buffer_load_dwordx4 v7, s[8:11], s92 offen lds
    buffer_load_dwordx4 v8, s[8:11], s92 offen offset:1024 lds
    s_add_u32 m0, s51, 8192
    s_add_u32 s92, s92, 16384
    buffer_load_dwordx4 v7, s[8:11], s92 offen lds
    buffer_load_dwordx4 v8, s[8:11], s92 offen offset:1024 lds
    s_add_u32 m0, s51, 10240
    s_add_u32 s92, s92, 16384
    buffer_load_dwordx4 v7, s[8:11], s92 offen lds
    buffer_load_dwordx4 v8, s[8:11], s92 offen offset:1024 lds
    s_add_u32 m0, s51, 12288
    s_add_u32 s92, s92, 16384
    buffer_load_dwordx4 v7, s[8:11], s92 offen lds
    buffer_load_dwordx4 v8, s[8:11], s92 offen offset:1024 lds
    s_add_u32 m0, s51, 14336
    s_add_u32 s92, s92, 16384
    buffer_load_dwordx4 v7, s[8:11], s92 offen lds
    buffer_load_dwordx4 v8, s[8:11], s92 offen offset:1024 lds
    s_cmp_lg_u32 s50, 7
    s_cbranch_scc1 L_c7_48
    s_cmp_ge_u32 s88, 4
    s_cbranch_scc1 L_c7_48
    s_call_b64 s[94:95], L_fpub
L_c7_48:
    s_lshr_b32 s52, s56, 1
    s_lshl_b32 s52, s52, 6
    v_lshl_add_u32 v12, v15, 9, v11
    v_xor_b32 v14, s52, v12
    v_add_u32 v12, s90, v14
    v_xor_b32 v13, 64, v12
    s_mul_i32 s89, s49, 229376
    s_mul_i32 s52, s56, 28672
    s_add_u32 s89, s89, s52
    s_add_u32 s89, s89, 1048576
    s_bitcmp1_b32 s56, 0
    s_cselect_b32 s51, 114688, 0
    s_add_u32 s89, s89, s51
    s_lshl_b32 s51, s51, 1
    s_sub_u32 s84, 114688, s51
    s_mul_i32 s52, s56, 7
    s_add_u32 s51, s56, 28
    v_add_u32 v3, s52, v1
    v_mov_b32 v4, s51
    v_cmp_gt_u32 vcc, 7, v1
    s_lshl_b32 s51, s49, 12
    s_add_u32 s51, s51, 262144
    v_cndmask_b32 v3, v4, v3, vcc
    v_lshlrev_b32 v3, 7, v3
    s_mov_b32 s3, 262144
L_fp_49:
    buffer_load_dwordx2 v[88:89], v3, s[32:35], s51 offen sc1
    s_sub_u32 s3, s3, 1
    s_waitcnt vmcnt(0)
    v_cmp_ne_u64 vcc, s[58:59], v[88:89]
    s_cbranch_vccz L_fpd_50
    s_sleep 8
    s_cbranch_scc0 L_fp_49
L_fpd_50:
    s_and_b32 s51, s56, 1
    s_lshl_b32 s52, s49, 1
    s_add_u32 s54, s51, s52
    s_lshl_b32 s54, s54, 15
    s_add_u32 s54, s54, 8388608
    s_add_u32 s87, s85, 0
    s_and_b32 s87, s87, 3
    s_mul_i32 s87, s87, 7168
    s_add_u32 s92, s87, s89
    s_add_u32 s93, s92, s84
    buffer_load_dwordx4 v[96:99], v2, s[32:35], s92 offen offset:0 sc1
    buffer_load_dwordx4 v[100:103], v2, s[32:35], s93 offen offset:0 sc1
    buffer_load_dwordx4 v[104:107], v2, s[32:35], s92 offen offset:1024 sc1
    buffer_load_dwordx4 v[108:111], v2, s[32:35], s93 offen offset:1024 sc1
    buffer_load_dwordx4 v[112:115], v2, s[32:35], s92 offen offset:2048 sc1
    buffer_load_dwordx4 v[116:119], v2, s[32:35], s93 offen offset:2048 sc1
    buffer_load_dwordx4 v[120:123], v2, s[32:35], s92 offen offset:3072 sc1
    buffer_load_dwordx4 v[124:127], v2, s[32:35], s93 offen offset:3072 sc1
    s_add_u32 s92, s92, 4096
    s_add_u32 s93, s93, 4096
    buffer_load_dwordx4 v[128:131], v2, s[32:35], s92 offen offset:0 sc1
    buffer_load_dwordx4 v[132:135], v2, s[32:35], s93 offen offset:0 sc1
    buffer_load_dwordx4 v[136:139], v2, s[32:35], s92 offen offset:1024 sc1
    buffer_load_dwordx4 v[140:143], v2, s[32:35], s93 offen offset:1024 sc1
    s_waitcnt lgkmcnt(0)
    v_mov_b32 v3, 1
    s_mov_b64 exec, 1
    ds_add_u32 v6, v3 offset:96
    s_mov_b64 exec, -1
    ds_read_b64_tr_b16 v[80:81], v12 offset:4096
    ds_read_b64_tr_b16 v[82:83], v12 offset:5120
    ds_read_b64_tr_b16 v[84:85], v13 offset:4096
    ds_read_b64_tr_b16 v[86:87], v13 offset:5120
    s_cmp_gt_u32 s88, 3
    s_cbranch_scc1 L_nt_51
    s_setprio 2
    s_call_b64 s[94:95], L_ftry
L_nt_51:
    s_setprio 1
    s_waitcnt vmcnt(10) lgkmcnt(0)
    v_mfma_f32_32x32x16_bf16 v[16:31], v[80:83], v[96:99], 0
    s_waitcnt vmcnt(12)
    ds_read_b64_tr_b16 v[88:89], v12 offset:6144
    ds_read_b64_tr_b16 v[90:91], v12 offset:7168
    ds_read_b64_tr_b16 v[92:93], v13 offset:6144
    ds_read_b64_tr_b16 v[94:95], v13 offset:7168
    v_mfma_f32_32x32x16_bf16 v[32:47], v[80:83], v[100:103], 0
    s_add_u32 m0, s90, 4096
    s_add_u32 s91, s91, 16384
    buffer_load_dwordx4 v7, s[44:47], s91 offen lds
    v_mfma_f32_32x32x16_bf16 v[64:79], v[84:87], v[100:103], 0
    buffer_load_dwordx4 v8, s[44:47], s91 offen offset:1024 lds
    v_mfma_f32_32x32x16_bf16 v[48:63], v[84:87], v[96:99], 0
    buffer_load_dwordx4 v[96:99], v2, s[32:35], s92 offen offset:2048 sc1
    buffer_load_dwordx4 v[100:103], v2, s[32:35], s93 offen offset:2048 sc1
    s_waitcnt vmcnt(12) lgkmcnt(0)
    v_mfma_f32_32x32x16_bf16 v[16:31], v[88:91], v[104:107], v[16:31]
    s_waitcnt vmcnt(16)
    ds_read_b64_tr_b16 v[80:81], v12 offset:8192
    ds_read_b64_tr_b16 v[82:83], v12 offset:9216
    ds_read_b64_tr_b16 v[84:85], v13 offset:8192
    ds_read_b64_tr_b16 v[86:87], v13 offset:9216
    v_mfma_f32_32x32x16_bf16 v[32:47], v[88:91], v[108:111], v[32:47]
    s_add_u32 m0, s90, 6144
    s_add_u32 s87, s85, 1
    s_and_b32 s87, s87, 3
    s_mul_i32 s87, s87, 114688
    s_add_u32 s91, s87, s86
    buffer_load_dwordx4 v7, s[44:47], s91 offen lds
    v_mfma_f32_32x32x16_bf16 v[64:79], v[92:95], v[108:111], v[64:79]
    buffer_load_dwordx4 v8, s[44:47], s91 offen offset:1024 lds
    v_mfma_f32_32x32x16_bf16 v[48:63], v[92:95], v[104:107], v[48:63]
    s_add_u32 s87, s85, 1
    s_and_b32 s87, s87, 3
    s_mul_i32 s87, s87, 7168
    s_add_u32 s92, s87, s89
    s_add_u32 s93, s92, s84
    buffer_load_dwordx4 v[104:107], v2, s[32:35], s92 offen offset:0 sc1
    buffer_load_dwordx4 v[108:111], v2, s[32:35], s93 offen offset:0 sc1
    s_waitcnt vmcnt(14) lgkmcnt(0)
    v_mfma_f32_32x32x16_bf16 v[16:31], v[80:83], v[112:115], v[16:31]
    s_waitcnt vmcnt(20)
    ds_read_b64_tr_b16 v[88:89], v12 offset:10240
    ds_read_b64_tr_b16 v[90:91], v12 offset:11264
    ds_read_b64_tr_b16 v[92:93], v13 offset:10240
    ds_read_b64_tr_b16 v[94:95], v13 offset:11264
    v_mfma_f32_32x32x16_bf16 v[32:47], v[80:83], v[116:119], v[32:47]
    s_add_u32 m0, s90, 8192
    s_add_u32 s91, s91, 16384
    buffer_load_dwordx4 v7, s[44:47], s91 offen lds
    v_mfma_f32_32x32x16_bf16 v[64:79], v[84:87], v[116:119], v[64:79]
    buffer_load_dwordx4 v8, s[44:47], s91 offen offset:1024 lds
    v_mfma_f32_32x32x16_bf16 v[48:63], v[84:87], v[112:115], v[48:63]
    buffer_load_dwordx4 v[112:115], v2, s[32:35], s92 offen offset:1024 sc1
    buffer_load_dwordx4 v[116:119], v2, s[32:35], s93 offen offset:1024 sc1
    s_waitcnt vmcnt(16) lgkmcnt(0)
    v_mfma_f32_32x32x16_bf16 v[16:31], v[88:91], v[120:123], v[16:31]
    s_waitcnt vmcnt(24)
    ds_read_b64_tr_b16 v[80:81], v12 offset:0
    ds_read_b64_tr_b16 v[82:83], v12 offset:1024
    ds_read_b64_tr_b16 v[84:85], v13 offset:0
    ds_read_b64_tr_b16 v[86:87], v13 offset:1024
    v_mfma_f32_32x32x16_bf16 v[32:47], v[88:91], v[124:127], v[32:47]
    s_add_u32 m0, s90, 10240
    s_add_u32 s91, s91, 16384
    buffer_load_dwordx4 v7, s[44:47], s91 offen lds
    v_mfma_f32_32x32x16_bf16 v[64:79], v[92:95], v[124:127], v[64:79]
    buffer_load_dwordx4 v8, s[44:47], s91 offen offset:1024 lds
    v_mfma_f32_32x32x16_bf16 v[48:63], v[92:95], v[120:123], v[48:63]
    buffer_load_dwordx4 v[120:123], v2, s[32:35], s92 offen offset:2048 sc1
    buffer_load_dwordx4 v[124:127], v2, s[32:35], s93 offen offset:2048 sc1
    s_waitcnt vmcnt(18) lgkmcnt(0)
    v_mfma_f32_32x32x16_bf16 v[16:31], v[80:83], v[128:131], v[16:31]
    s_waitcnt vmcnt(28)
    ds_read_b64_tr_b16 v[88:89], v12 offset:2048
    ds_read_b64_tr_b16 v[90:91], v12 offset:3072
    ds_read_b64_tr_b16 v[92:93], v13 offset:2048
    ds_read_b64_tr_b16 v[94:95], v13 offset:3072
    v_mfma_f32_32x32x16_bf16 v[32:47], v[80:83], v[132:135], v[32:47]
    s_add_u32 m0, s90, 0
    s_add_u32 s91, s91, 16384
    buffer_load_dwordx4 v7, s[44:47], s91 offen lds
    v_mfma_f32_32x32x16_bf16 v[64:79], v[84:87], v[132:135], v[64:79]
    buffer_load_dwordx4 v8, s[44:47], s91 offen offset:1024 lds
    v_mfma_f32_32x32x16_bf16 v[48:63], v[84:87], v[128:131], v[48:63]
    buffer_load_dwordx4 v[128:131], v2, s[32:35], s92 offen offset:3072 sc1
    buffer_load_dwordx4 v[132:135], v2, s[32:35], s93 offen offset:3072 sc1
    s_waitcnt vmcnt(20) lgkmcnt(0)
    v_mfma_f32_32x32x16_bf16 v[16:31], v[88:91], v[136:139], v[16:31]
    s_waitcnt vmcnt(18)
    ds_read_b64_tr_b16 v[80:81], v12 offset:4096
    ds_read_b64_tr_b16 v[82:83], v12 offset:5120
    ds_read_b64_tr_b16 v[84:85], v13 offset:4096
    ds_read_b64_tr_b16 v[86:87], v13 offset:5120
    v_mfma_f32_32x32x16_bf16 v[32:47], v[88:91], v[140:143], v[32:47]
    s_add_u32 m0, s90, 2048
    s_add_u32 s91, s91, 16384
    buffer_load_dwordx4 v7, s[44:47], s91 offen lds
    v_mfma_f32_32x32x16_bf16 v[64:79], v[92:95], v[140:143], v[64:79]
    buffer_load_dwordx4 v8, s[44:47], s91 offen offset:1024 lds
    v_mfma_f32_32x32x16_bf16 v[48:63], v[92:95], v[136:139], v[48:63]
    s_add_u32 s92, s92, 4096
    s_add_u32 s93, s93, 4096
    buffer_load_dwordx4 v[136:139], v2, s[32:35], s92 offen offset:0 sc1
    buffer_load_dwordx4 v[140:143], v2, s[32:35], s93 offen offset:0 sc1
    s_cmp_gt_u32 s88, 3
    s_cbranch_scc1 L_nt_52
    s_setprio 2
    s_call_b64 s[94:95], L_ftry
L_nt_52:
    s_setprio 1
    s_waitcnt vmcnt(20) lgkmcnt(0)
    v_mfma_f32_32x32x16_bf16 v[16:31], v[80:83], v[96:99], v[16:31]
    s_waitcnt vmcnt(18)
    ds_read_b64_tr_b16 v[88:89], v12 offset:6144
    ds_read_b64_tr_b16 v[90:91], v12 offset:7168
    ds_read_b64_tr_b16 v[92:93], v13 offset:6144
    ds_read_b64_tr_b16 v[94:95], v13 offset:7168
    v_mfma_f32_32x32x16_bf16 v[32:47], v[80:83], v[100:103], v[32:47]
    s_add_u32 m0, s90, 4096
    s_add_u32 s91, s91, 16384
    buffer_load_dwordx4 v7, s[44:47], s91 offen lds
    v_mfma_f32_32x32x16_bf16 v[64:79], v[84:87], v[100:103], v[64:79]
    buffer_load_dwordx4 v8, s[44:47], s91 offen offset:1024 lds
    v_mfma_f32_32x32x16_bf16 v[48:63], v[84:87], v[96:99], v[48:63]
    buffer_load_dwordx4 v[96:99], v2, s[32:35], s92 offen offset:1024 sc1
    buffer_load_dwordx4 v[100:103], v2, s[32:35], s93 offen offset:1024 sc1
    s_waitcnt vmcnt(20) lgkmcnt(0)
    v_mfma_f32_32x32x16_bf16 v[16:31], v[88:91], v[104:107], v[16:31]
    s_waitcnt vmcnt(18)
    ds_read_b64_tr_b16 v[80:81], v12 offset:8192
    ds_read_b64_tr_b16 v[82:83], v12 offset:9216
    ds_read_b64_tr_b16 v[84:85], v13 offset:8192
    ds_read_b64_tr_b16 v[86:87], v13 offset:9216
    v_mfma_f32_32x32x16_bf16 v[32:47], v[88:91], v[108:111], v[32:47]
    s_add_u32 m0, s90, 6144
    s_add_u32 s91, s91, 16384
    buffer_load_dwordx4 v7, s[44:47], s91 offen lds
    v_mfma_f32_32x32x16_bf16 v[64:79], v[92:95], v[108:111], v[64:79]
    buffer_load_dwordx4 v8, s[44:47], s91 offen offset:1024 lds
    v_mfma_f32_32x32x16_bf16 v[48:63], v[92:95], v[104:107], v[48:63]
    buffer_load_dwordx4 v[104:107], v2, s[32:35], s92 offen offset:2048 sc1
    buffer_load_dwordx4 v[108:111], v2, s[32:35], s93 offen offset:2048 sc1
    s_waitcnt vmcnt(20) lgkmcnt(0)
    v_mfma_f32_32x32x16_bf16 v[16:31], v[80:83], v[112:115], v[16:31]
    s_waitcnt vmcnt(18)
    ds_read_b64_tr_b16 v[88:89], v12 offset:10240
    ds_read_b64_tr_b16 v[90:91], v12 offset:11264
    ds_read_b64_tr_b16 v[92:93], v13 offset:10240
    ds_read_b64_tr_b16 v[94:95], v13 offset:11264
    v_mfma_f32_32x32x16_bf16 v[32:47], v[80:83], v[116:119], v[32:47]
    s_add_u32 m0, s90, 8192
    s_add_u32 s87, s85, 2
    s_and_b32 s87, s87, 3
    s_mul_i32 s87, s87, 114688
    s_add_u32 s91, s87, s86
    buffer_load_dwordx4 v7, s[44:47], s91 offen lds
    v_mfma_f32_32x32x16_bf16 v[64:79], v[84:87], v[116:119], v[64:79]
    buffer_load_dwordx4 v8, s[44:47], s91 offen offset:1024 lds
    v_mfma_f32_32x32x16_bf16 v[48:63], v[84:87], v[112:115], v[48:63]
    s_add_u32 s87, s85, 2
    s_and_b32 s87, s87, 3
    s_mul_i32 s87, s87, 7168
    s_add_u32 s92, s87, s89
    s_add_u32 s93, s92, s84
    buffer_load_dwordx4 v[112:115], v2, s[32:35], s92 offen offset:0 sc1
    buffer_load_dwordx4 v[116:119], v2, s[32:35], s93 offen offset:0 sc1
    s_waitcnt vmcnt(20) lgkmcnt(0)
    v_mfma_f32_32x32x16_bf16 v[16:31], v[88:91], v[120:123], v[16:31]
    s_waitcnt vmcnt(18)
    ds_read_b64_tr_b16 v[80:81], v12 offset:0
    ds_read_b64_tr_b16 v[82:83], v12 offset:1024
    ds_read_b64_tr_b16 v[84:85], v13 offset:0
    ds_read_b64_tr_b16 v[86:87], v13 offset:1024
    v_mfma_f32_32x32x16_bf16 v[32:47], v[88:91], v[124:127], v[32:47]
    s_add_u32 m0, s90, 10240
    s_add_u32 s91, s91, 16384
    buffer_load_dwordx4 v7, s[44:47], s91 offen lds
    v_mfma_f32_32x32x16_bf16 v[64:79], v[92:95], v[124:127], v[64:79]
    buffer_load_dwordx4 v8, s[44:47], s91 offen offset:1024 lds
    v_mfma_f32_32x32x16_bf16 v[48:63], v[92:95], v[120:123], v[48:63]
    buffer_load_dwordx4 v[120:123], v2, s[32:35], s92 offen offset:1024 sc1
    buffer_load_dwordx4 v[124:127], v2, s[32:35], s93 offen offset:1024 sc1
    s_waitcnt vmcnt(20) lgkmcnt(0)
    v_mfma_f32_32x32x16_bf16 v[16:31], v[80:83], v[128:131], v[16:31]
    s_waitcnt vmcnt(18)
    ds_read_b64_tr_b16 v[88:89], v12 offset:2048
    ds_read_b64_tr_b16 v[90:91], v12 offset:3072
    ds_read_b64_tr_b16 v[92:93], v13 offset:2048
    ds_read_b64_tr_b16 v[94:95], v13 offset:3072
    v_mfma_f32_32x32x16_bf16 v[32:47], v[80:83], v[132:135], v[32:47]
    s_add_u32 m0, s90, 0
    s_add_u32 s91, s91, 16384
    buffer_load_dwordx4 v7, s[44:47], s91 offen lds
    v_mfma_f32_32x32x16_bf16 v[64:79], v[84:87], v[132:135], v[64:79]
    buffer_load_dwordx4 v8, s[44:47], s91 offen offset:1024 lds
    v_mfma_f32_32x32x16_bf16 v[48:63], v[84:87], v[128:131], v[48:63]
    buffer_load_dwordx4 v[128:131], v2, s[32:35], s92 offen offset:2048 sc1
    buffer_load_dwordx4 v[132:135], v2, s[32:35], s93 offen offset:2048 sc1
    s_waitcnt vmcnt(20) lgkmcnt(0)
    v_mfma_f32_32x32x16_bf16 v[16:31], v[88:91], v[136:139], v[16:31]
    s_waitcnt vmcnt(18)
    ds_read_b64_tr_b16 v[80:81], v12 offset:4096
    ds_read_b64_tr_b16 v[82:83], v12 offset:5120
    ds_read_b64_tr_b16 v[84:85], v13 offset:4096
    ds_read_b64_tr_b16 v[86:87], v13 offset:5120
    v_mfma_f32_32x32x16_bf16 v[32:47], v[88:91], v[140:143], v[32:47]
    s_add_u32 m0, s90, 2048
    s_add_u32 s91, s91, 16384
    buffer_load_dwordx4 v7, s[44:47], s91 offen lds
    v_mfma_f32_32x32x16_bf16 v[64:79], v[92:95], v[140:143], v[64:79]
    buffer_load_dwordx4 v8, s[44:47], s91 offen offset:1024 lds
    v_mfma_f32_32x32x16_bf16 v[48:63], v[92:95], v[136:139], v[48:63]
    buffer_load_dwordx4 v[136:139], v2, s[32:35], s92 offen offset:3072 sc1
    buffer_load_dwordx4 v[140:143], v2, s[32:35], s93 offen offset:3072 sc1
    s_cmp_gt_u32 s88, 4
    s_cbranch_scc1 L_nt_53
    s_setprio 2
    s_call_b64 s[94:95], L_ftry
L_nt_53:
    s_setprio 1
    s_waitcnt vmcnt(20) lgkmcnt(0)
    v_mfma_f32_32x32x16_bf16 v[16:31], v[80:83], v[96:99], v[16:31]
    s_waitcnt vmcnt(18)
    ds_read_b64_tr_b16 v[88:89], v12 offset:6144
    ds_read_b64_tr_b16 v[90:91], v12 offset:7168
    ds_read_b64_tr_b16 v[92:93], v13 offset:6144
    ds_read_b64_tr_b16 v[94:95], v13 offset:7168
    v_mfma_f32_32x32x16_bf16 v[32:47], v[80:83], v[100:103], v[32:47]
    s_add_u32 m0, s90, 4096
    s_add_u32 s91, s91, 16384
    buffer_load_dwordx4 v7, s[44:47], s91 offen lds
    v_mfma_f32_32x32x16_bf16 v[64:79], v[84:87], v[100:103], v[64:79]
    buffer_load_dwordx4 v8, s[44:47], s91 offen offset:1024 lds
    v_mfma_f32_32x32x16_bf16 v[48:63], v[84:87], v[96:99], v[48:63]
    s_add_u32 s92, s92, 4096
    s_add_u32 s93, s93, 4096
    buffer_load_dwordx4 v[96:99], v2, s[32:35], s92 offen offset:0 sc1
    buffer_load_dwordx4 v[100:103], v2, s[32:35], s93 offen offset:0 sc1
    s_waitcnt vmcnt(20) lgkmcnt(0)
    v_mfma_f32_32x32x16_bf16 v[16:31], v[88:91], v[104:107], v[16:31]
    s_waitcnt vmcnt(18)
    ds_read_b64_tr_b16 v[80:81], v12 offset:8192
    ds_read_b64_tr_b16 v[82:83], v12 offset:9216
    ds_read_b64_tr_b16 v[84:85], v13 offset:8192
    ds_read_b64_tr_b16 v[86:87], v13 offset:9216
    v_mfma_f32_32x32x16_bf16 v[32:47], v[88:91], v[108:111], v[32:47]
    s_add_u32 m0, s90, 6144
    s_add_u32 s91, s91, 16384
    buffer_load_dwordx4 v7, s[44:47], s91 offen lds
    v_mfma_f32_32x32x16_bf16 v[64:79], v[92:95], v[108:111], v[64:79]
    buffer_load_dwordx4 v8, s[44:47], s91 offen offset:1024 lds
    v_mfma_f32_32x32x16_bf16 v[48:63], v[92:95], v[104:107], v[48:63]
    buffer_load_dwordx4 v[104:107], v2, s[32:35], s92 offen offset:1024 sc1
    buffer_load_dwordx4 v[108:111], v2, s[32:35], s93 offen offset:1024 sc1
    s_waitcnt vmcnt(20) lgkmcnt(0)
    v_mfma_f32_32x32x16_bf16 v[16:31], v[80:83], v[112:115], v[16:31]
    s_waitcnt vmcnt(18)
    ds_read_b64_tr_b16 v[88:89], v12 offset:10240
    ds_read_b64_tr_b16 v[90:91], v12 offset:11264
    ds_read_b64_tr_b16 v[92:93], v13 offset:10240
    ds_read_b64_tr_b16 v[94:95], v13 offset:11264
    v_mfma_f32_32x32x16_bf16 v[32:47], v[80:83], v[116:119], v[32:47]
    s_add_u32 m0, s90, 8192
    s_add_u32 s91, s91, 16384
    buffer_load_dwordx4 v7, s[44:47], s91 offen lds
    v_mfma_f32_32x32x16_bf16 v[64:79], v[84:87], v[116:119], v[64:79]
    buffer_load_dwordx4 v8, s[44:47], s91 offen offset:1024 lds
    v_mfma_f32_32x32x16_bf16 v[48:63], v[84:87], v[112:115], v[48:63]
    buffer_load_dwordx4 v[112:115], v2, s[32:35], s92 offen offset:2048 sc1
    buffer_load_dwordx4 v[116:119], v2, s[32:35], s93 offen offset:2048 sc1
    s_waitcnt vmcnt(20) lgkmcnt(0)
    v_mfma_f32_32x32x16_bf16 v[16:31], v[88:91], v[120:123], v[16:31]
    s_waitcnt vmcnt(18)
    ds_read_b64_tr_b16 v[80:81], v12 offset:0
    ds_read_b64_tr_b16 v[82:83], v12 offset:1024
    ds_read_b64_tr_b16 v[84:85], v13 offset:0
    ds_read_b64_tr_b16 v[86:87], v13 offset:1024
    v_mfma_f32_32x32x16_bf16 v[32:47], v[88:91], v[124:127], v[32:47]
    s_add_u32 m0, s90, 10240
    s_add_u32 s87, s85, 3
    s_and_b32 s87, s87, 3
    s_mul_i32 s87, s87, 114688
    s_add_u32 s91, s87, s86
    buffer_load_dwordx4 v7, s[44:47], s91 offen lds
    v_mfma_f32_32x32x16_bf16 v[64:79], v[92:95], v[124:127], v[64:79]
    buffer_load_dwordx4 v8, s[44:47], s91 offen offset:1024 lds
    v_mfma_f32_32x32x16_bf16 v[48:63], v[92:95], v[120:123], v[48:63]
    s_add_u32 s87, s85, 3
    s_and_b32 s87, s87, 3
    s_mul_i32 s87, s87, 7168
    s_add_u32 s92, s87, s89
    s_add_u32 s93, s92, s84
    buffer_load_dwordx4 v[120:123], v2, s[32:35], s92 offen offset:0 sc1
    buffer_load_dwordx4 v[124:127], v2, s[32:35], s93 offen offset:0 sc1
    s_waitcnt vmcnt(20) lgkmcnt(0)
    v_mfma_f32_32x32x16_bf16 v[16:31], v[80:83], v[128:131], v[16:31]
    s_waitcnt vmcnt(18)
    ds_read_b64_tr_b16 v[88:89], v12 offset:2048
    ds_read_b64_tr_b16 v[90:91], v12 offset:3072
    ds_read_b64_tr_b16 v[92:93], v13 offset:2048
    ds_read_b64_tr_b16 v[94:95], v13 offset:3072
    v_mfma_f32_32x32x16_bf16 v[32:47], v[80:83], v[132:135], v[32:47]
    s_add_u32 m0, s90, 0
    s_add_u32 s91, s91, 16384
    buffer_load_dwordx4 v7, s[44:47], s91 offen lds
    v_mfma_f32_32x32x16_bf16 v[64:79], v[84:87], v[132:135], v[64:79]
    buffer_load_dwordx4 v8, s[44:47], s91 offen offset:1024 lds
    v_mfma_f32_32x32x16_bf16 v[48:63], v[84:87], v[128:131], v[48:63]
    buffer_load_dwordx4 v[128:131], v2, s[32:35], s92 offen offset:1024 sc1
    buffer_load_dwordx4 v[132:135], v2, s[32:35], s93 offen offset:1024 sc1
    s_waitcnt vmcnt(20) lgkmcnt(0)
    v_mfma_f32_32x32x16_bf16 v[16:31], v[88:91], v[136:139], v[16:31]
    s_waitcnt vmcnt(18)
    ds_read_b64_tr_b16 v[80:81], v12 offset:4096
    ds_read_b64_tr_b16 v[82:83], v12 offset:5120
    ds_read_b64_tr_b16 v[84:85], v13 offset:4096
    ds_read_b64_tr_b16 v[86:87], v13 offset:5120
    v_mfma_f32_32x32x16_bf16 v[32:47], v[88:91], v[140:143], v[32:47]
    s_add_u32 m0, s90, 2048
    s_add_u32 s91, s91, 16384
    buffer_load_dwordx4 v7, s[44:47], s91 offen lds
    v_mfma_f32_32x32x16_bf16 v[64:79], v[92:95], v[140:143], v[64:79]
    buffer_load_dwordx4 v8, s[44:47], s91 offen offset:1024 lds
    v_mfma_f32_32x32x16_bf16 v[48:63], v[92:95], v[136:139], v[48:63]
    buffer_load_dwordx4 v[136:139], v2, s[32:35], s92 offen offset:2048 sc1
    buffer_load_dwordx4 v[140:143], v2, s[32:35], s93 offen offset:2048 sc1
    s_cmp_gt_u32 s88, 4
    s_cbranch_scc1 L_nt_54
    s_setprio 2
    s_call_b64 s[94:95], L_ftry
L_nt_54:
    s_setprio 1
    s_waitcnt vmcnt(20) lgkmcnt(0)
    v_mfma_f32_32x32x16_bf16 v[16:31], v[80:83], v[96:99], v[16:31]
    s_waitcnt vmcnt(18)
    ds_read_b64_tr_b16 v[88:89], v12 offset:6144
    ds_read_b64_tr_b16 v[90:91], v12 offset:7168
    ds_read_b64_tr_b16 v[92:93], v13 offset:6144
    ds_read_b64_tr_b16 v[94:95], v13 offset:7168
    v_mfma_f32_32x32x16_bf16 v[32:47], v[80:83], v[100:103], v[32:47]
    s_add_u32 m0, s90, 4096
    s_add_u32 s91, s91, 16384
    buffer_load_dwordx4 v7, s[44:47], s91 offen lds
    v_mfma_f32_32x32x16_bf16 v[64:79], v[84:87], v[100:103], v[64:79]
    buffer_load_dwordx4 v8, s[44:47], s91 offen offset:1024 lds
    v_mfma_f32_32x32x16_bf16 v[48:63], v[84:87], v[96:99], v[48:63]
    buffer_load_dwordx4 v[96:99], v2, s[32:35], s92 offen offset:3072 sc1
    buffer_load_dwordx4 v[100:103], v2, s[32:35], s93 offen offset:3072 sc1
    s_waitcnt vmcnt(20) lgkmcnt(0)
    v_mfma_f32_32x32x16_bf16 v[16:31], v[88:91], v[104:107], v[16:31]
    s_waitcnt vmcnt(18)
    ds_read_b64_tr_b16 v[80:81], v12 offset:8192
    ds_read_b64_tr_b16 v[82:83], v12 offset:9216
    ds_read_b64_tr_b16 v[84:85], v13 offset:8192
    ds_read_b64_tr_b16 v[86:87], v13 offset:9216
    v_mfma_f32_32x32x16_bf16 v[32:47], v[88:91], v[108:111], v[32:47]
    s_add_u32 m0, s90, 6144
    s_add_u32 s91, s91, 16384
    buffer_load_dwordx4 v7, s[44:47], s91 offen lds
    v_mfma_f32_32x32x16_bf16 v[64:79], v[92:95], v[108:111], v[64:79]
    buffer_load_dwordx4 v8, s[44:47], s91 offen offset:1024 lds
    v_mfma_f32_32x32x16_bf16 v[48:63], v[92:95], v[104:107], v[48:63]
    s_add_u32 s92, s92, 4096
    s_add_u32 s93, s93, 4096
    buffer_load_dwordx4 v[104:107], v2, s[32:35], s92 offen offset:0 sc1
    buffer_load_dwordx4 v[108:111], v2, s[32:35], s93 offen offset:0 sc1
    s_waitcnt vmcnt(20) lgkmcnt(0)
    s_setprio 2
    s_mov_b32 s3, 2097152
L_lw_55:
    ds_read_b32 v5, v6 offset:96
    s_sub_u32 s3, s3, 1
    s_waitcnt lgkmcnt(0)
    v_cmp_gt_u32 vcc, 4, v5
    s_cbranch_vccz L_lwd_56
    s_sleep 2
    s_cbranch_scc0 L_lw_55
L_lwd_56:
    s_setprio 1
    v_mfma_f32_32x32x16_bf16 v[16:31], v[80:83], v[112:115], v[16:31]
    s_waitcnt vmcnt(18)
    ds_read_b64_tr_b16 v[88:89], v12 offset:10240
    ds_read_b64_tr_b16 v[90:91], v12 offset:11264
    ds_read_b64_tr_b16 v[92:93], v13 offset:10240
    ds_read_b64_tr_b16 v[94:95], v13 offset:11264
    v_mfma_f32_32x32x16_bf16 v[32:47], v[80:83], v[116:119], v[32:47]
    s_add_u32 m0, s90, 8192
    s_add_u32 s91, s91, 16384
    buffer_load_dwordx4 v7, s[44:47], s91 offen lds
    v_mfma_f32_32x32x16_bf16 v[64:79], v[84:87], v[116:119], v[64:79]
    buffer_load_dwordx4 v8, s[44:47], s91 offen offset:1024 lds
    v_mfma_f32_32x32x16_bf16 v[48:63], v[84:87], v[112:115], v[48:63]
    buffer_load_dwordx4 v[112:115], v2, s[32:35], s92 offen offset:1024 sc1
    buffer_load_dwordx4 v[116:119], v2, s[32:35], s93 offen offset:1024 sc1
    s_waitcnt vmcnt(20) lgkmcnt(0)
    v_mfma_f32_32x32x16_bf16 v[16:31], v[88:91], v[120:123], v[16:31]
    s_waitcnt vmcnt(18)
    ds_read_b64_tr_b16 v[80:81], v12 offset:0
    ds_read_b64_tr_b16 v[82:83], v12 offset:1024
    ds_read_b64_tr_b16 v[84:85], v13 offset:0
    ds_read_b64_tr_b16 v[86:87], v13 offset:1024
    v_mfma_f32_32x32x16_bf16 v[32:47], v[88:91], v[124:127], v[32:47]
    s_add_u32 m0, s90, 10240
    s_add_u32 s91, s91, 16384
    buffer_load_dwordx4 v7, s[44:47], s91 offen lds
    v_mfma_f32_32x32x16_bf16 v[64:79], v[92:95], v[124:127], v[64:79]
    buffer_load_dwordx4 v8, s[44:47], s91 offen offset:1024 lds
    v_mfma_f32_32x32x16_bf16 v[48:63], v[92:95], v[120:123], v[48:63]
    buffer_load_dwordx4 v[120:123], v2, s[32:35], s92 offen offset:2048 sc1
    buffer_load_dwordx4 v[124:127], v2, s[32:35], s93 offen offset:2048 sc1
    s_waitcnt vmcnt(20) lgkmcnt(0)
    v_mfma_f32_32x32x16_bf16 v[16:31], v[80:83], v[128:131], v[16:31]
    s_waitcnt vmcnt(18)
    ds_read_b64_tr_b16 v[88:89], v12 offset:2048
    ds_read_b64_tr_b16 v[90:91], v12 offset:3072
    ds_read_b64_tr_b16 v[92:93], v13 offset:2048
    ds_read_b64_tr_b16 v[94:95], v13 offset:3072
    v_mfma_f32_32x32x16_bf16 v[32:47], v[80:83], v[132:135], v[32:47]
    v_mfma_f32_32x32x16_bf16 v[64:79], v[84:87], v[132:135], v[64:79]
    v_mfma_f32_32x32x16_bf16 v[48:63], v[84:87], v[128:131], v[48:63]
    s_add_u32 s87, s54, 8192
    buffer_load_dwordx4 v[128:131], v2, s[32:35], s87 offen offset:0 sc1
    buffer_load_dwordx4 v[132:135], v2, s[32:35], s87 offen offset:1024 sc1
    s_waitcnt vmcnt(18) lgkmcnt(0)
    v_mfma_f32_32x32x16_bf16 v[16:31], v[88:91], v[136:139], v[16:31]
    s_waitcnt vmcnt(16)
    ds_read_b64_tr_b16 v[80:81], v12 offset:4096
    ds_read_b64_tr_b16 v[82:83], v12 offset:5120
    ds_read_b64_tr_b16 v[84:85], v13 offset:4096
    ds_read_b64_tr_b16 v[86:87], v13 offset:5120
    v_mfma_f32_32x32x16_bf16 v[32:47], v[88:91], v[140:143], v[32:47]
    v_mfma_f32_32x32x16_bf16 v[64:79], v[92:95], v[140:143], v[64:79]
    v_mfma_f32_32x32x16_bf16 v[48:63], v[92:95], v[136:139], v[48:63]
    s_add_u32 s87, s54, 10240
    buffer_load_dwordx4 v[136:139], v2, s[32:35], s87 offen offset:0 sc1
    buffer_load_dwordx4 v[140:143], v2, s[32:35], s87 offen offset:1024 sc1
    s_cmp_gt_u32 s88, 5
    s_cbranch_scc1 L_nt_57
    s_setprio 2
    s_call_b64 s[94:95], L_ftry
L_nt_57:
    s_setprio 1
    s_waitcnt vmcnt(16) lgkmcnt(0)
    v_mfma_f32_32x32x16_bf16 v[16:31], v[80:83], v[96:99], v[16:31]
    s_waitcnt vmcnt(14)
    ds_read_b64_tr_b16 v[88:89], v12 offset:6144
    ds_read_b64_tr_b16 v[90:91], v12 offset:7168
    ds_read_b64_tr_b16 v[92:93], v13 offset:6144
    ds_read_b64_tr_b16 v[94:95], v13 offset:7168
    v_mfma_f32_32x32x16_bf16 v[32:47], v[80:83], v[100:103], v[32:47]
    v_mfma_f32_32x32x16_bf16 v[64:79], v[84:87], v[100:103], v[64:79]
    v_mfma_f32_32x32x16_bf16 v[48:63], v[84:87], v[96:99], v[48:63]
    s_add_u32 s87, s54, 0
    buffer_load_dwordx4 v[96:99], v2, s[32:35], s87 offen offset:0 sc1
    buffer_load_dwordx4 v[100:103], v2, s[32:35], s87 offen offset:1024 sc1
    s_waitcnt vmcnt(14) lgkmcnt(0)
    v_mfma_f32_32x32x16_bf16 v[16:31], v[88:91], v[104:107], v[16:31]
    s_waitcnt vmcnt(12)
    ds_read_b64_tr_b16 v[80:81], v12 offset:8192
    ds_read_b64_tr_b16 v[82:83], v12 offset:9216
    ds_read_b64_tr_b16 v[84:85], v13 offset:8192
    ds_read_b64_tr_b16 v[86:87], v13 offset:9216
    v_mfma_f32_32x32x16_bf16 v[32:47], v[88:91], v[108:111], v[32:47]
    v_mfma_f32_32x32x16_bf16 v[64:79], v[92:95], v[108:111], v[64:79]
    v_mfma_f32_32x32x16_bf16 v[48:63], v[92:95], v[104:107], v[48:63]
    s_add_u32 s87, s54, 2048
    buffer_load_dwordx4 v[104:107], v2, s[32:35], s87 offen offset:0 sc1
    buffer_load_dwordx4 v[108:111], v2, s[32:35], s87 offen offset:1024 sc1
    s_waitcnt vmcnt(12) lgkmcnt(0)
    v_mfma_f32_32x32x16_bf16 v[16:31], v[80:83], v[112:115], v[16:31]
    s_waitcnt vmcnt(10)
    ds_read_b64_tr_b16 v[88:89], v12 offset:10240
    ds_read_b64_tr_b16 v[90:91], v12 offset:11264
    ds_read_b64_tr_b16 v[92:93], v13 offset:10240
    ds_read_b64_tr_b16 v[94:95], v13 offset:11264
    v_mfma_f32_32x32x16_bf16 v[32:47], v[80:83], v[116:119], v[32:47]
    v_mfma_f32_32x32x16_bf16 v[64:79], v[84:87], v[116:119], v[64:79]
    v_mfma_f32_32x32x16_bf16 v[48:63], v[84:87], v[112:115], v[48:63]
    s_add_u32 s87, s54, 4096
    buffer_load_dwordx4 v[112:115], v2, s[32:35], s87 offen offset:0 sc1
    buffer_load_dwordx4 v[116:119], v2, s[32:35], s87 offen offset:1024 sc1
    s_waitcnt vmcnt(10) lgkmcnt(0)
    v_mfma_f32_32x32x16_bf16 v[16:31], v[88:91], v[120:123], v[16:31]
    v_mfma_f32_32x32x16_bf16 v[32:47], v[88:91], v[124:127], v[32:47]
    v_mfma_f32_32x32x16_bf16 v[64:79], v[92:95], v[124:127], v[64:79]
    v_mfma_f32_32x32x16_bf16 v[48:63], v[92:95], v[120:123], v[48:63]
    s_add_u32 s87, s54, 6144
    buffer_load_dwordx4 v[120:123], v2, s[32:35], s87 offen offset:0 sc1
    buffer_load_dwordx4 v[124:127], v2, s[32:35], s87 offen offset:1024 sc1
    s_setprio 2
    s_lshr_b32 s51, s56, 1
    s_lshl_b32 s52, s50, 1
    s_add_u32 s51, s51, s52
    s_lshl_b32 s91, s51, 6
    s_and_b32 s51, s56, 1
    s_lshl_b32 s52, s49, 1
    s_add_u32 s93, s51, s52
    s_lshl_b32 s92, s93, 15
    s_add_u32 s91, s91, s92
    s_add_u32 s92, s92, 8388608
    v_add_u32 v3, s90, v2
    ds_write_b128 v3, v[32:35] offset:0
    ds_write_b128 v3, v[36:39] offset:1024
    ds_write_b128 v3, v[40:43] offset:2048
    ds_write_b128 v3, v[44:47] offset:3072
    ds_write_b128 v3, v[64:67] offset:8192
    ds_write_b128 v3, v[68:71] offset:9216
    ds_write_b128 v3, v[72:75] offset:10240
    ds_write_b128 v3, v[76:79] offset:11264
    ds_write_b128 v3, v[48:51] offset:4096
    ds_write_b128 v3, v[52:55] offset:5120
    ds_write_b128 v3, v[56:59] offset:6144
    ds_write_b128 v3, v[60:63] offset:7168
    s_waitcnt lgkmcnt(0)
    v_mov_b32 v5, 1
    s_mov_b64 exec, 1
    ds_add_u32 v6, v5 offset:24
    s_mov_b64 exec, -1
L_p2_58:
    s_cmp_ge_u32 s88, 7
    s_cbranch_scc1 L_p3_59
    s_call_b64 s[94:95], L_fpub
    s_branch L_p2_58
L_p3_59:
    s_add_u32 s51, s92, 12288
    buffer_load_dwordx4 v[144:147], v2, s[32:35], s51 offen offset:0 sc1
    buffer_load_dwordx4 v[148:151], v2, s[32:35], s51 offen offset:1024 sc1
    buffer_load_dwordx4 v[152:155], v2, s[32:35], s51 offen offset:2048 sc1
    buffer_load_dwordx4 v[156:159], v2, s[32:35], s51 offen offset:3072 sc1
    v_and_b32 v9, 31, v1
    v_lshlrev_b32 v9, 10, v9
    v_lshl_add_u32 v9, v15, 3, v9
    buffer_load_dwordx2 v[80:81], v9, s[28:31], s91 offen offset:0
    buffer_load_dwordx2 v[82:83], v9, s[28:31], s91 offen offset:16
    buffer_load_dwordx2 v[84:85], v9, s[28:31], s91 offen offset:32
    buffer_load_dwordx2 v[86:87], v9, s[28:31], s91 offen offset:48
    s_xor_b32 s51, s56, 1
    s_mul_i32 s51, s51, 12288
    s_add_u32 s51, s51, 67584
    v_add_u32 v89, s51, v2
    s_xor_b32 s51, s56, 2
    s_mul_i32 s51, s51, 12288
    s_add_u32 s51, s51, 71680
    v_add_u32 v90, s51, v2
    s_xor_b32 s51, s56, 3
    s_mul_i32 s51, s51, 12288
    s_add_u32 s51, s51, 75776
    v_add_u32 v91, s51, v2
    s_mov_b32 s3, 2097152
L_lw_60:
    ds_read_b32 v5, v6 offset:24
    s_sub_u32 s3, s3, 1
    s_waitcnt lgkmcnt(0)
    v_cmp_gt_u32 vcc, 4, v5
    s_cbranch_vccz L_lwd_61
    s_sleep 2
    s_cbranch_scc0 L_lw_60
L_lwd_61:
    ds_read_b128 v[32:35], v89 offset:0
    ds_read_b128 v[36:39], v89 offset:1024
    ds_read_b128 v[40:43], v89 offset:2048
    ds_read_b128 v[44:47], v89 offset:3072
    ds_read_b128 v[48:51], v90 offset:0
    ds_read_b128 v[52:55], v90 offset:1024
    ds_read_b128 v[56:59], v90 offset:2048
    ds_read_b128 v[60:63], v90 offset:3072
    ds_read_b128 v[64:67], v91 offset:0
    ds_read_b128 v[68:71], v91 offset:1024
    ds_read_b128 v[72:75], v91 offset:2048
    ds_read_b128 v[76:79], v91 offset:3072
    s_and_b32 s51, s56, 1
    s_lshl_b32 s51, s51, 7
    s_add_u32 s51, s51, 163072
    v_and_b32 v4, 31, v1
    v_lshl_add_u32 v4, v4, 2, s51
    ds_read_b32 v4, v4
    s_waitcnt lgkmcnt(0)
    v_pk_add_f32 v[16:17], v[16:17], v[32:33]
    v_pk_add_f32 v[48:49], v[48:49], v[64:65]
    v_pk_add_f32 v[18:19], v[18:19], v[34:35]
    v_pk_add_f32 v[50:51], v[50:51], v[66:67]
    v_pk_add_f32 v[20:21], v[20:21], v[36:37]
    v_pk_add_f32 v[52:53], v[52:53], v[68:69]
    v_pk_add_f32 v[22:23], v[22:23], v[38:39]
    v_pk_add_f32 v[54:55], v[54:55], v[70:71]
    v_pk_add_f32 v[24:25], v[24:25], v[40:41]
    v_pk_add_f32 v[56:57], v[56:57], v[72:73]
    v_pk_add_f32 v[26:27], v[26:27], v[42:43]
    v_pk_add_f32 v[58:59], v[58:59], v[74:75]
    v_pk_add_f32 v[28:29], v[28:29], v[44:45]
    v_pk_add_f32 v[60:61], v[60:61], v[76:77]
    v_pk_add_f32 v[30:31], v[30:31], v[46:47]
    v_pk_add_f32 v[62:63], v[62:63], v[78:79]
    v_pk_add_f32 v[16:17], v[16:17], v[48:49]
    v_pk_add_f32 v[18:19], v[18:19], v[50:51]
    v_pk_add_f32 v[20:21], v[20:21], v[52:53]
    v_pk_add_f32 v[22:23], v[22:23], v[54:55]
    v_pk_add_f32 v[24:25], v[24:25], v[56:57]
    v_pk_add_f32 v[26:27], v[26:27], v[58:59]
    v_pk_add_f32 v[28:29], v[28:29], v[60:61]
    v_pk_add_f32 v[30:31], v[30:31], v[62:63]
    s_and_b32 s51, s56, 1
    s_lshl_b32 s51, s51, 9
    s_add_u32 s51, s51, 152576
    v_mov_b32 v12, s51
    s_add_u32 s51, s92, 16384
    buffer_load_dwordx4 v[64:67], v2, s[32:35], s51 offen offset:0 sc1
    buffer_load_dwordx4 v[68:71], v2, s[32:35], s51 offen offset:1024 sc1
    buffer_load_dwordx4 v[72:75], v2, s[32:35], s51 offen offset:2048 sc1
    buffer_load_dwordx4 v[76:79], v2, s[32:35], s51 offen offset:3072 sc1
    s_add_u32 s51, s51, 4096
    buffer_load_dwordx4 v[88:91], v2, s[32:35], s51 offen offset:0 sc1
    buffer_load_dwordx4 v[92:95], v2, s[32:35], s51 offen offset:1024 sc1
    buffer_load_dwordx4 v[160:163], v2, s[32:35], s51 offen offset:2048 sc1
    buffer_load_dwordx4 v[164:167], v2, s[32:35], s51 offen offset:3072 sc1
    ds_read_b64_tr_b16 v[48:49], v14 offset:0
    ds_read_b64_tr_b16 v[50:51], v14 offset:1024
    ds_read_b64_tr_b16 v[52:53], v14 offset:8192
    ds_read_b64_tr_b16 v[54:55], v14 offset:9216
    ds_read_b64_tr_b16 v[56:57], v14 offset:16384
    ds_read_b64_tr_b16 v[58:59], v14 offset:17408
    ds_read_b64_tr_b16 v[60:61], v14 offset:24576
    ds_read_b64_tr_b16 v[62:63], v14 offset:25600
    s_setprio 0
    s_mov_b32 s55, 0xff
    s_add_u32 s93, s92, 2121728
    s_add_u32 s90, s93, 4096
    v_mul_f32 v5, 0xbfb8aa3b, v4
    v_pk_mul_f32 v[32:33], v[16:17], v[4:5] op_sel:[0,1] op_sel_hi:[1,1]
    v_pk_mul_f32 v[34:35], v[18:19], v[4:5] op_sel:[0,1] op_sel_hi:[1,1]
    v_pk_mul_f32 v[36:37], v[20:21], v[4:5] op_sel:[0,1] op_sel_hi:[1,1]
    v_pk_mul_f32 v[38:39], v[22:23], v[4:5] op_sel:[0,1] op_sel_hi:[1,1]
    v_pk_mul_f32 v[40:41], v[24:25], v[4:5] op_sel:[0,1] op_sel_hi:[1,1]
    v_pk_mul_f32 v[42:43], v[26:27], v[4:5] op_sel:[0,1] op_sel_hi:[1,1]
    v_pk_mul_f32 v[44:45], v[28:29], v[4:5] op_sel:[0,1] op_sel_hi:[1,1]
    v_pk_mul_f32 v[46:47], v[30:31], v[4:5] op_sel:[0,1] op_sel_hi:[1,1]
    v_exp_f32 v32, v32
    v_exp_f32 v33, v33
    v_exp_f32 v34, v34
    v_exp_f32 v35, v35
    v_exp_f32 v36, v36
    v_exp_f32 v37, v37
    v_exp_f32 v38, v38
    v_exp_f32 v39, v39
    v_exp_f32 v40, v40
    v_exp_f32 v41, v41
    v_exp_f32 v42, v42
    v_exp_f32 v43, v43
    v_exp_f32 v44, v44
    v_exp_f32 v45, v45
    v_exp_f32 v46, v46
    v_exp_f32 v47, v47
    v_rcp_f32 v4, v4
    s_nop 0
    v_pk_fma_f32 v[32:33], v[32:33], v[4:5], v[4:5] op_sel_hi:[1,0,0]
    v_pk_fma_f32 v[34:35], v[34:35], v[4:5], v[4:5] op_sel_hi:[1,0,0]
    v_pk_fma_f32 v[36:37], v[36:37], v[4:5], v[4:5] op_sel_hi:[1,0,0]
    v_pk_fma_f32 v[38:39], v[38:39], v[4:5], v[4:5] op_sel_hi:[1,0,0]
    v_pk_fma_f32 v[40:41], v[40:41], v[4:5], v[4:5] op_sel_hi:[1,0,0]
    v_pk_fma_f32 v[42:43], v[42:43], v[4:5], v[4:5] op_sel_hi:[1,0,0]
    v_pk_fma_f32 v[44:45], v[44:45], v[4:5], v[4:5] op_sel_hi:[1,0,0]
    v_pk_fma_f32 v[46:47], v[46:47], v[4:5], v[4:5] op_sel_hi:[1,0,0]
    v_rcp_f32 v32, v32
    v_rcp_f32 v33, v33
    v_rcp_f32 v34, v34
    v_rcp_f32 v35, v35
    v_rcp_f32 v36, v36
    v_rcp_f32 v37, v37
    v_rcp_f32 v38, v38
    v_rcp_f32 v39, v39
    v_rcp_f32 v40, v40
    v_rcp_f32 v41, v41
    v_rcp_f32 v42, v42
    v_rcp_f32 v43, v43
    v_rcp_f32 v44, v44
    v_rcp_f32 v45, v45
    v_rcp_f32 v46, v46
    v_rcp_f32 v47, v47
    v_pk_mul_f32 v[16:17], v[16:17], v[32:33]
    v_pk_mul_f32 v[18:19], v[18:19], v[34:35]
    v_pk_mul_f32 v[20:21], v[20:21], v[36:37]
    v_pk_mul_f32 v[22:23], v[22:23], v[38:39]
    v_pk_mul_f32 v[24:25], v[24:25], v[40:41]
    v_pk_mul_f32 v[26:27], v[26:27], v[42:43]
    v_pk_mul_f32 v[28:29], v[28:29], v[44:45]
    v_pk_mul_f32 v[30:31], v[30:31], v[46:47]
    s_mov_b32 s3, 262144
    s_waitcnt vmcnt(8)
L_vf_62:
    v_max_u32 v4, v96, v97
    v_max3_u32 v4, v98, v99, v4
    v_max3_u32 v4, v100, v101, v4
    v_max3_u32 v4, v102, v103, v4
    v_max3_u32 v4, v104, v105, v4
    v_max3_u32 v4, v106, v107, v4
    v_max3_u32 v4, v108, v109, v4
    v_max3_u32 v4, v110, v111, v4
    v_max3_u32 v4, v112, v113, v4
    v_max3_u32 v4, v114, v115, v4
    v_max3_u32 v4, v116, v117, v4
    v_max3_u32 v4, v118, v119, v4
    v_max3_u32 v4, v120, v121, v4
    v_max3_u32 v4, v122, v123, v4
    v_max3_u32 v4, v124, v125, v4
    v_max3_u32 v4, v126, v127, v4
    v_max3_u32 v4, v128, v129, v4
    v_max3_u32 v4, v130, v131, v4
    v_max3_u32 v4, v132, v133, v4
    v_max3_u32 v4, v134, v135, v4
    v_max3_u32 v4, v136, v137, v4
    v_max3_u32 v4, v138, v139, v4
    v_max3_u32 v4, v140, v141, v4
    v_max3_u32 v4, v142, v143, v4
    v_max3_u32 v4, v144, v145, v4
    v_max3_u32 v4, v146, v147, v4
    v_max3_u32 v4, v148, v149, v4
    v_max3_u32 v4, v150, v151, v4
    v_max3_u32 v4, v152, v153, v4
    v_max3_u32 v4, v154, v155, v4
    v_max3_u32 v4, v156, v157, v4
    v_max3_u32 v4, v158, v159, v4
    v_cmp_eq_u32 vcc, -1, v4
    s_cbranch_vccz L_vfd_63
    s_sleep 4
    s_add_u32 s51, s92, 0
    buffer_load_dwordx4 v[96:99], v2, s[32:35], s51 offen offset:0 sc1
    buffer_load_dwordx4 v[100:103], v2, s[32:35], s51 offen offset:1024 sc1
    buffer_load_dwordx4 v[104:107], v2, s[32:35], s51 offen offset:2048 sc1
    buffer_load_dwordx4 v[108:111], v2, s[32:35], s51 offen offset:3072 sc1
    s_add_u32 s51, s51, 4096
    buffer_load_dwordx4 v[112:115], v2, s[32:35], s51 offen offset:0 sc1
    buffer_load_dwordx4 v[116:119], v2, s[32:35], s51 offen offset:1024 sc1
    buffer_load_dwordx4 v[120:123], v2, s[32:35], s51 offen offset:2048 sc1
    buffer_load_dwordx4 v[124:127], v2, s[32:35], s51 offen offset:3072 sc1
    s_add_u32 s51, s51, 4096
    buffer_load_dwordx4 v[128:131], v2, s[32:35], s51 offen offset:0 sc1
    buffer_load_dwordx4 v[132:135], v2, s[32:35], s51 offen offset:1024 sc1
    buffer_load_dwordx4 v[136:139], v2, s[32:35], s51 offen offset:2048 sc1
    buffer_load_dwordx4 v[140:143], v2, s[32:35], s51 offen offset:3072 sc1
    s_add_u32 s51, s51, 4096
    buffer_load_dwordx4 v[144:147], v2, s[32:35], s51 offen offset:0 sc1
    buffer_load_dwordx4 v[148:151], v2, s[32:35], s51 offen offset:1024 sc1
    buffer_load_dwordx4 v[152:155], v2, s[32:35], s51 offen offset:2048 sc1
    buffer_load_dwordx4 v[156:159], v2, s[32:35], s51 offen offset:3072 sc1
    s_waitcnt vmcnt(0)
    s_sub_u32 s3, s3, 1
    s_cbranch_scc0 L_vf_62
L_vfd_63:
    s_mov_b32 s3, 262144
    s_waitcnt vmcnt(0)
L_vf_64:
    v_max_u32 v4, v64, v65
    v_max3_u32 v4, v66, v67, v4
    v_max3_u32 v4, v68, v69, v4
    v_max3_u32 v4, v70, v71, v4
    v_max3_u32 v4, v72, v73, v4
    v_max3_u32 v4, v74, v75, v4
    v_max3_u32 v4, v76, v77, v4
    v_max3_u32 v4, v78, v79, v4
    v_max3_u32 v4, v88, v89, v4
    v_max3_u32 v4, v90, v91, v4
    v_max3_u32 v4, v92, v93, v4
    v_max3_u32 v4, v94, v95, v4
    v_max3_u32 v4, v160, v161, v4
    v_max3_u32 v4, v162, v163, v4
    v_max3_u32 v4, v164, v165, v4
    v_max3_u32 v4, v166, v167, v4
    v_cmp_eq_u32 vcc, -1, v4
    s_cbranch_vccz L_vfd_65
    s_sleep 4
    s_add_u32 s51, s92, 16384
    buffer_load_dwordx4 v[64:67], v2, s[32:35], s51 offen offset:0 sc1
    buffer_load_dwordx4 v[68:71], v2, s[32:35], s51 offen offset:1024 sc1
    buffer_load_dwordx4 v[72:75], v2, s[32:35], s51 offen offset:2048 sc1
    buffer_load_dwordx4 v[76:79], v2, s[32:35], s51 offen offset:3072 sc1
    s_add_u32 s51, s51, 4096
    buffer_load_dwordx4 v[88:91], v2, s[32:35], s51 offen offset:0 sc1
    buffer_load_dwordx4 v[92:95], v2, s[32:35], s51 offen offset:1024 sc1
    buffer_load_dwordx4 v[160:163], v2, s[32:35], s51 offen offset:2048 sc1
    buffer_load_dwordx4 v[164:167], v2, s[32:35], s51 offen offset:3072 sc1
    s_waitcnt vmcnt(0)
    s_sub_u32 s3, s3, 1
    s_cbranch_scc0 L_vf_64
L_vfd_65:
    s_waitcnt lgkmcnt(6)
    v_mfma_f32_32x32x16_bf16 v[32:47], v[48:51], v[96:99], 0
    ds_read_b64_tr_b16 v[48:49], v14 offset:32768
    ds_read_b64_tr_b16 v[50:51], v14 offset:33792
    s_waitcnt lgkmcnt(6)
    v_mfma_f32_32x32x16_bf16 v[32:47], v[52:55], v[100:103], v[32:47]
    ds_read_b64_tr_b16 v[52:53], v14 offset:40960
    ds_read_b64_tr_b16 v[54:55], v14 offset:41984
    s_waitcnt lgkmcnt(6)
    v_mfma_f32_32x32x16_bf16 v[32:47], v[56:59], v[104:107], v[32:47]
    ds_read_b64_tr_b16 v[56:57], v14 offset:49152
    ds_read_b64_tr_b16 v[58:59], v14 offset:50176
    s_waitcnt lgkmcnt(6)
    v_mfma_f32_32x32x16_bf16 v[32:47], v[60:63], v[108:111], v[32:47]
    ds_read_b64_tr_b16 v[60:61], v14 offset:57344
    ds_read_b64_tr_b16 v[62:63], v14 offset:58368
    s_waitcnt lgkmcnt(6)
    v_mfma_f32_32x32x16_bf16 v[32:47], v[48:51], v[112:115], v[32:47]
    ds_read_b64_tr_b16 v[48:49], v14 offset:2048
    ds_read_b64_tr_b16 v[50:51], v14 offset:3072
    s_waitcnt lgkmcnt(6)
    v_mfma_f32_32x32x16_bf16 v[32:47], v[52:55], v[116:119], v[32:47]
    ds_read_b64_tr_b16 v[52:53], v14 offset:10240
    ds_read_b64_tr_b16 v[54:55], v14 offset:11264
    s_waitcnt lgkmcnt(6)
    v_mfma_f32_32x32x16_bf16 v[32:47], v[56:59], v[120:123], v[32:47]
    ds_read_b64_tr_b16 v[56:57], v14 offset:18432
    ds_read_b64_tr_b16 v[58:59], v14 offset:19456
    s_waitcnt lgkmcnt(6)
    v_mfma_f32_32x32x16_bf16 v[32:47], v[60:63], v[124:127], v[32:47]
    ds_read_b64_tr_b16 v[60:61], v14 offset:26624
    ds_read_b64_tr_b16 v[62:63], v14 offset:27648
    s_waitcnt lgkmcnt(6)
    v_mfma_f32_32x32x16_bf16 v[32:47], v[48:51], v[128:131], v[32:47]
    ds_read_b64_tr_b16 v[48:49], v14 offset:34816
    ds_read_b64_tr_b16 v[50:51], v14 offset:35840
    s_waitcnt lgkmcnt(6)
    v_mfma_f32_32x32x16_bf16 v[32:47], v[52:55], v[132:135], v[32:47]
    ds_read_b64_tr_b16 v[52:53], v14 offset:43008
    ds_read_b64_tr_b16 v[54:55], v14 offset:44032
    s_waitcnt lgkmcnt(6)
    v_mfma_f32_32x32x16_bf16 v[32:47], v[56:59], v[136:139], v[32:47]
    ds_read_b64_tr_b16 v[56:57], v14 offset:51200
    ds_read_b64_tr_b16 v[58:59], v14 offset:52224
    s_waitcnt lgkmcnt(6)
    v_mfma_f32_32x32x16_bf16 v[32:47], v[60:63], v[140:143], v[32:47]
    ds_read_b64_tr_b16 v[60:61], v14 offset:59392
    ds_read_b64_tr_b16 v[62:63], v14 offset:60416
    s_waitcnt lgkmcnt(6)
    v_mfma_f32_32x32x16_bf16 v[32:47], v[48:51], v[144:147], v[32:47]
    ds_read_b64_tr_b16 v[48:49], v14 offset:4096
    ds_read_b64_tr_b16 v[50:51], v14 offset:5120
    s_waitcnt lgkmcnt(6)
    v_mfma_f32_32x32x16_bf16 v[32:47], v[52:55], v[148:151], v[32:47]
    ds_read_b64_tr_b16 v[52:53], v14 offset:12288
    ds_read_b64_tr_b16 v[54:55], v14 offset:13312
    s_waitcnt lgkmcnt(6)
    v_mfma_f32_32x32x16_bf16 v[32:47], v[56:59], v[152:155], v[32:47]
    ds_read_b64_tr_b16 v[56:57], v14 offset:20480
    ds_read_b64_tr_b16 v[58:59], v14 offset:21504
    s_waitcnt lgkmcnt(6)
    v_mfma_f32_32x32x16_bf16 v[32:47], v[60:63], v[156:159], v[32:47]
    ds_read_b64_tr_b16 v[60:61], v14 offset:28672
    ds_read_b64_tr_b16 v[62:63], v14 offset:29696
    buffer_load_dwordx4 v[96:99], v2, s[32:35], s93 offen offset:0 sc1
    buffer_load_dwordx4 v[100:103], v2, s[32:35], s93 offen offset:1024 sc1
    buffer_load_dwordx4 v[104:107], v2, s[32:35], s93 offen offset:2048 sc1
    buffer_load_dwordx4 v[108:111], v2, s[32:35], s93 offen offset:3072 sc1
    buffer_load_dwordx4 v[112:115], v2, s[32:35], s90 offen offset:0 sc1
    buffer_load_dwordx4 v[116:119], v2, s[32:35], s90 offen offset:1024 sc1
    buffer_load_dwordx4 v[120:123], v2, s[32:35], s90 offen offset:2048 sc1
    buffer_load_dwordx4 v[124:127], v2, s[32:35], s90 offen offset:3072 sc1
    s_waitcnt lgkmcnt(6)
    v_mfma_f32_32x32x16_bf16 v[32:47], v[48:51], v[64:67], v[32:47]
    ds_read_b64_tr_b16 v[48:49], v14 offset:36864
    ds_read_b64_tr_b16 v[50:51], v14 offset:37888
    s_waitcnt lgkmcnt(6)
    v_mfma_f32_32x32x16_bf16 v[32:47], v[52:55], v[68:71], v[32:47]
    ds_read_b64_tr_b16 v[52:53], v14 offset:45056
    ds_read_b64_tr_b16 v[54:55], v14 offset:46080
    s_waitcnt lgkmcnt(6)
    v_mfma_f32_32x32x16_bf16 v[32:47], v[56:59], v[72:75], v[32:47]
    ds_read_b64_tr_b16 v[56:57], v14 offset:53248
    ds_read_b64_tr_b16 v[58:59], v14 offset:54272
    s_waitcnt lgkmcnt(6)
    v_mfma_f32_32x32x16_bf16 v[32:47], v[60:63], v[76:79], v[32:47]
    ds_read_b64_tr_b16 v[60:61], v14 offset:61440
    ds_read_b64_tr_b16 v[62:63], v14 offset:62464
    s_waitcnt lgkmcnt(6)
    v_mfma_f32_32x32x16_bf16 v[32:47], v[48:51], v[88:91], v[32:47]
    ds_read_b64_tr_b16 v[48:49], v14 offset:6144
    ds_read_b64_tr_b16 v[50:51], v14 offset:7168
    s_waitcnt lgkmcnt(6)
    v_mfma_f32_32x32x16_bf16 v[32:47], v[52:55], v[92:95], v[32:47]
    ds_read_b64_tr_b16 v[52:53], v14 offset:14336
    ds_read_b64_tr_b16 v[54:55], v14 offset:15360
    s_waitcnt lgkmcnt(6)
    v_mfma_f32_32x32x16_bf16 v[32:47], v[56:59], v[160:163], v[32:47]
    ds_read_b64_tr_b16 v[56:57], v14 offset:22528
    ds_read_b64_tr_b16 v[58:59], v14 offset:23552
    s_waitcnt lgkmcnt(6)
    v_mfma_f32_32x32x16_bf16 v[32:47], v[60:63], v[164:167], v[32:47]
    ds_read_b64_tr_b16 v[60:61], v14 offset:30720
    ds_read_b64_tr_b16 v[62:63], v14 offset:31744
    v_lshlrev_b32 v64, 16, v80
    v_and_b32 v65, 0xffff0000, v80
    v_lshlrev_b32 v66, 16, v81
    v_and_b32 v67, 0xffff0000, v81
    v_lshlrev_b32 v68, 16, v82
    v_and_b32 v69, 0xffff0000, v82
    v_lshlrev_b32 v70, 16, v83
    v_and_b32 v71, 0xffff0000, v83
    v_lshlrev_b32 v72, 16, v84
    v_and_b32 v73, 0xffff0000, v84
    v_lshlrev_b32 v74, 16, v85
    v_and_b32 v75, 0xffff0000, v85
    v_lshlrev_b32 v76, 16, v86
    v_and_b32 v77, 0xffff0000, v86
    v_lshlrev_b32 v78, 16, v87
    v_and_b32 v79, 0xffff0000, v87
    s_mov_b32 s88, 262144
    s_waitcnt vmcnt(0)
    v_max_u32 v4, v96, v97
    v_max3_u32 v4, v98, v99, v4
    v_max3_u32 v4, v100, v101, v4
    v_max3_u32 v4, v102, v103, v4
    v_max3_u32 v4, v104, v105, v4
    v_max3_u32 v4, v106, v107, v4
    v_max3_u32 v4, v108, v109, v4
    v_max3_u32 v4, v110, v111, v4
    v_max3_u32 v4, v112, v113, v4
    v_max3_u32 v4, v114, v115, v4
    v_max3_u32 v4, v116, v117, v4
    v_max3_u32 v4, v118, v119, v4
    v_max3_u32 v4, v120, v121, v4
    v_max3_u32 v4, v122, v123, v4
    v_max3_u32 v4, v124, v125, v4
    v_max3_u32 v4, v126, v127, v4
    v_cmp_eq_u32 vcc, -1, v4
    s_cbranch_vccz L_gmd_75
    s_mov_b32 s3, 2097152
L_lw_77:
    ds_read_b32 v4, v12 offset:260
    s_sub_u32 s3, s3, 1
    s_waitcnt lgkmcnt(0)
    v_cmp_gt_u32 vcc, 1075838976, v4
    s_cbranch_vccz L_lwd_78
    s_sleep 2
    s_cbranch_scc0 L_lw_77
L_lwd_78:
    s_setprio 3
    s_mov_b32 s52, 8
L_ga_76:
    buffer_load_dwordx4 v[96:99], v2, s[32:35], s93 offen offset:0 sc1
    buffer_load_dwordx4 v[100:103], v2, s[32:35], s93 offen offset:1024 sc1
    buffer_load_dwordx4 v[104:107], v2, s[32:35], s93 offen offset:2048 sc1
    buffer_load_dwordx4 v[108:111], v2, s[32:35], s93 offen offset:3072 sc1
    buffer_load_dwordx4 v[112:115], v2, s[32:35], s90 offen offset:0 sc1
    buffer_load_dwordx4 v[116:119], v2, s[32:35], s90 offen offset:1024 sc1
    buffer_load_dwordx4 v[120:123], v2, s[32:35], s90 offen offset:2048 sc1
    buffer_load_dwordx4 v[124:127], v2, s[32:35], s90 offen offset:3072 sc1
    s_waitcnt vmcnt(0)
    v_max_u32 v4, v96, v97
    v_max3_u32 v4, v98, v99, v4
    v_max3_u32 v4, v100, v101, v4
    v_max3_u32 v4, v102, v103, v4
    v_max3_u32 v4, v104, v105, v4
    v_max3_u32 v4, v106, v107, v4
    v_max3_u32 v4, v108, v109, v4
    v_max3_u32 v4, v110, v111, v4
    v_max3_u32 v4, v112, v113, v4
    v_max3_u32 v4, v114, v115, v4
    v_max3_u32 v4, v116, v117, v4
    v_max3_u32 v4, v118, v119, v4
    v_max3_u32 v4, v120, v121, v4
    v_max3_u32 v4, v122, v123, v4
    v_max3_u32 v4, v124, v125, v4
    v_max3_u32 v4, v126, v127, v4
    v_cmp_eq_u32 vcc, -1, v4
    s_cbranch_vccz L_gmd_75
    s_sub_u32 s52, s52, 1
    s_cbranch_scc0 L_ga_76
L_gm_74:
    s_waitcnt vmcnt(0)
    s_bitcmp1_b32 s55, 0
    s_cbranch_scc0 L_gc_87
    v_max_u32 v4, v96, v97
    v_max3_u32 v4, v98, v99, v4
    v_cmp_eq_u32 vcc, -1, v4
    s_cbranch_vccnz L_gc_87
    s_bitset0_b32 s55, 0
L_gc_87:
    s_bitcmp1_b32 s55, 1
    s_cbranch_scc0 L_gc_88
    v_max_u32 v4, v100, v101
    v_max3_u32 v4, v102, v103, v4
    v_cmp_eq_u32 vcc, -1, v4
    s_cbranch_vccnz L_gc_88
    s_bitset0_b32 s55, 1
L_gc_88:
    s_bitcmp1_b32 s55, 2
    s_cbranch_scc0 L_gc_89
    v_max_u32 v4, v104, v105
    v_max3_u32 v4, v106, v107, v4
    v_cmp_eq_u32 vcc, -1, v4
    s_cbranch_vccnz L_gc_89
    s_bitset0_b32 s55, 2
L_gc_89:
    s_bitcmp1_b32 s55, 3
    s_cbranch_scc0 L_gc_90
    v_max_u32 v4, v108, v109
    v_max3_u32 v4, v110, v111, v4
    v_cmp_eq_u32 vcc, -1, v4
    s_cbranch_vccnz L_gc_90
    s_bitset0_b32 s55, 3
L_gc_90:
    s_bitcmp1_b32 s55, 4
    s_cbranch_scc0 L_gc_91
    v_max_u32 v4, v112, v113
    v_max3_u32 v4, v114, v115, v4
    v_cmp_eq_u32 vcc, -1, v4
    s_cbranch_vccnz L_gc_91
    s_bitset0_b32 s55, 4
L_gc_91:
    s_bitcmp1_b32 s55, 5
    s_cbranch_scc0 L_gc_92
    v_max_u32 v4, v116, v117
    v_max3_u32 v4, v118, v119, v4
    v_cmp_eq_u32 vcc, -1, v4
    s_cbranch_vccnz L_gc_92
    s_bitset0_b32 s55, 5
L_gc_92:
    s_bitcmp1_b32 s55, 6
    s_cbranch_scc0 L_gc_93
    v_max_u32 v4, v120, v121
    v_max3_u32 v4, v122, v123, v4
    v_cmp_eq_u32 vcc, -1, v4
    s_cbranch_vccnz L_gc_93
    s_bitset0_b32 s55, 6
L_gc_93:
    s_bitcmp1_b32 s55, 7
    s_cbranch_scc0 L_gc_94
    v_max_u32 v4, v124, v125
    v_max3_u32 v4, v126, v127, v4
    v_cmp_eq_u32 vcc, -1, v4
    s_cbranch_vccnz L_gc_94
    s_bitset0_b32 s55, 7
L_gc_94:
    s_cmp_eq_u32 s55, 0
    s_cbranch_scc1 L_gmd_75
    s_mov_b32 s3, 2097152
L_lw_95:
    ds_read_b32 v4, v12 offset:260
    s_sub_u32 s3, s3, 1
    s_waitcnt lgkmcnt(0)
    v_cmp_gt_u32 vcc, 1075838976, v4
    s_cbranch_vccz L_lwd_96
    s_sleep 2
    s_cbranch_scc0 L_lw_95
L_lwd_96:
    s_setprio 3
    s_and_b32 s51, s88, 7
    s_cmp_eq_u32 s51, 1
    s_cselect_b32 s51, 0, 2097152
    s_add_u32 s93, s92, s51
    s_add_u32 s93, s93, 24576
    s_add_u32 s90, s93, 4096
    s_bitcmp1_b32 s55, 0
    s_cbranch_scc0 L_gs_97
    buffer_load_dwordx4 v[96:99], v2, s[32:35], s93 offen offset:0 sc1
L_gs_97:
    s_bitcmp1_b32 s55, 1
    s_cbranch_scc0 L_gs_98
    buffer_load_dwordx4 v[100:103], v2, s[32:35], s93 offen offset:1024 sc1
L_gs_98:
    s_bitcmp1_b32 s55, 2
    s_cbranch_scc0 L_gs_99
    buffer_load_dwordx4 v[104:107], v2, s[32:35], s93 offen offset:2048 sc1
L_gs_99:
    s_bitcmp1_b32 s55, 3
    s_cbranch_scc0 L_gs_100
    buffer_load_dwordx4 v[108:111], v2, s[32:35], s93 offen offset:3072 sc1
L_gs_100:
    s_bitcmp1_b32 s55, 4
    s_cbranch_scc0 L_gs_101
    buffer_load_dwordx4 v[112:115], v2, s[32:35], s90 offen offset:0 sc1
L_gs_101:
    s_bitcmp1_b32 s55, 5
    s_cbranch_scc0 L_gs_102
    buffer_load_dwordx4 v[116:119], v2, s[32:35], s90 offen offset:1024 sc1
L_gs_102:
    s_bitcmp1_b32 s55, 6
    s_cbranch_scc0 L_gs_103
    buffer_load_dwordx4 v[120:123], v2, s[32:35], s90 offen offset:2048 sc1
L_gs_103:
    s_bitcmp1_b32 s55, 7
    s_cbranch_scc0 L_gs_104
    buffer_load_dwordx4 v[124:127], v2, s[32:35], s90 offen offset:3072 sc1
L_gs_104:
    s_sub_u32 s88, s88, 1
    s_cbranch_scc0 L_gm_74
    s_waitcnt vmcnt(0)
L_gmd_75:
    s_setprio 3
    s_waitcnt lgkmcnt(6)
    v_mfma_f32_32x32x16_bf16 v[32:47], v[48:51], v[96:99], v[32:47]
    ds_read_b64_tr_b16 v[48:49], v14 offset:38912
    ds_read_b64_tr_b16 v[50:51], v14 offset:39936
    s_waitcnt lgkmcnt(6)
    v_mfma_f32_32x32x16_bf16 v[32:47], v[52:55], v[100:103], v[32:47]
    ds_read_b64_tr_b16 v[52:53], v14 offset:47104
    ds_read_b64_tr_b16 v[54:55], v14 offset:48128
    s_waitcnt lgkmcnt(6)
    v_mfma_f32_32x32x16_bf16 v[32:47], v[56:59], v[104:107], v[32:47]
    ds_read_b64_tr_b16 v[56:57], v14 offset:55296
    ds_read_b64_tr_b16 v[58:59], v14 offset:56320
    s_waitcnt lgkmcnt(6)
    v_mfma_f32_32x32x16_bf16 v[32:47], v[60:63], v[108:111], v[32:47]
    ds_read_b64_tr_b16 v[60:61], v14 offset:63488
    ds_read_b64_tr_b16 v[62:63], v14 offset:64512
    s_waitcnt lgkmcnt(6)
    v_mfma_f32_32x32x16_bf16 v[32:47], v[48:51], v[112:115], v[32:47]
    s_waitcnt lgkmcnt(4)
    v_mfma_f32_32x32x16_bf16 v[32:47], v[52:55], v[116:119], v[32:47]
    s_waitcnt lgkmcnt(2)
    v_mfma_f32_32x32x16_bf16 v[32:47], v[56:59], v[120:123], v[32:47]
    s_waitcnt lgkmcnt(0)
    v_mfma_f32_32x32x16_bf16 v[32:47], v[60:63], v[124:127], v[32:47]
    s_nop 11
    v_pk_fma_f32 v[32:33], v[32:33], v[16:17], v[64:65]
    v_pk_fma_f32 v[34:35], v[34:35], v[18:19], v[66:67]
    v_pk_fma_f32 v[36:37], v[36:37], v[20:21], v[68:69]
    v_pk_fma_f32 v[38:39], v[38:39], v[22:23], v[70:71]
    v_pk_fma_f32 v[40:41], v[40:41], v[24:25], v[72:73]
    v_pk_fma_f32 v[42:43], v[42:43], v[26:27], v[74:75]
    v_pk_fma_f32 v[44:45], v[44:45], v[28:29], v[76:77]
    v_pk_fma_f32 v[46:47], v[46:47], v[30:31], v[78:79]
    v_cvt_pk_bf16_f32 v32, v32, v33
    v_cvt_pk_bf16_f32 v33, v34, v35
    v_cvt_pk_bf16_f32 v34, v36, v37
    v_cvt_pk_bf16_f32 v35, v38, v39
    v_cvt_pk_bf16_f32 v36, v40, v41
    v_cvt_pk_bf16_f32 v37, v42, v43
    v_cvt_pk_bf16_f32 v38, v44, v45
    v_cvt_pk_bf16_f32 v39, v46, v47
    v_lshl_add_u32 v9, v15, 3, v9
    s_nop 0
    v_permlane32_swap_b32 v32, v34
    v_permlane32_swap_b32 v33, v35
    buffer_store_dwordx4 v[32:35], v9, s[40:43], s91 offen offset:0
    v_permlane32_swap_b32 v36, v38
    v_permlane32_swap_b32 v37, v39
    buffer_store_dwordx4 v[36:39], v9, s[40:43], s91 offen offset:32
    s_xor_b32 s51, s56, 3
    s_or_b32 s51, s51, s2
    s_cmp_lg_u32 s51, 0
    s_cbranch_scc1 L_ne_105
    s_mov_b32 s51, 135168
    v_mov_b32 v96, s58
    v_mov_b32 v97, s59
    v_mov_b32 v98, 0
    s_waitcnt vmcnt(0)
    s_mov_b64 exec, 1
    buffer_store_dwordx2 v[96:97], v98, s[32:35], s51 offen sc1
    s_mov_b64 exec, -1
L_ne_105:
    s_endpgm
L_ftry:
    s_cmp_ge_u32 s88, 7
    s_cbranch_scc1 L_fret
    s_lshl_b32 s51, s88, 9
    s_add_u32 s51, s51, 149504
    v_mov_b32 v5, s51
    ds_read_b32 v4, v5 offset:260
    s_waitcnt lgkmcnt(0)
    v_cmp_ne_u32 vcc, 1075838976, v4
    s_cbranch_vccz L_fgo
L_fret:
    s_setpc_b64 s[94:95]
L_fpub:
    s_lshl_b32 s51, s88, 9
    s_add_u32 s51, s51, 149504
    v_mov_b32 v5, s51
    s_mov_b32 s3, 2097152
L_lw_106:
    ds_read_b32 v4, v5 offset:260
    s_sub_u32 s3, s3, 1
    s_waitcnt lgkmcnt(0)
    v_cmp_ne_u32 vcc, 1075838976, v4
    s_cbranch_vccz L_lwd_107
    s_sleep 4
    s_cbranch_scc0 L_lw_106
L_lwd_107:
L_fgo:
    s_and_b32 s52, s88, 3
    s_lshl_b32 s52, s52, 13
    s_add_u32 s52, s52, 116736
    v_add_u32 v3, s52, v2
    ds_read_b128 v[88:91], v3 offset:0
    ds_read_b128 v[92:95], v3 offset:1024
    ds_read_b128 v[164:167], v3 offset:2048
    v_and_b32 v4, 31, v1
    v_lshl_add_u32 v4, v4, 3, v5
    s_waitcnt lgkmcnt(2)
    v_mfma_f32_32x32x16_bf16 v[148:163], v[144:147], v[88:91], 0
    ds_read_b128 v[88:91], v3 offset:3072
    s_waitcnt lgkmcnt(2)
    v_mfma_f32_32x32x16_bf16 v[148:163], v[144:147], v[92:95], v[148:163]
    ds_read_b128 v[92:95], v3 offset:4096
    s_waitcnt lgkmcnt(2)
    v_mfma_f32_32x32x16_bf16 v[148:163], v[144:147], v[164:167], v[148:163]
    ds_read_b128 v[164:167], v3 offset:5120
    s_waitcnt lgkmcnt(2)
    v_mfma_f32_32x32x16_bf16 v[148:163], v[144:147], v[88:91], v[148:163]
    ds_read_b128 v[88:91], v3 offset:6144
    s_waitcnt lgkmcnt(2)
    v_mfma_f32_32x32x16_bf16 v[148:163], v[144:147], v[92:95], v[148:163]
    ds_read_b128 v[92:95], v3 offset:7168
    s_waitcnt lgkmcnt(2)
    v_mfma_f32_32x32x16_bf16 v[148:163], v[144:147], v[164:167], v[148:163]
    s_waitcnt lgkmcnt(1)
    v_mfma_f32_32x32x16_bf16 v[148:163], v[144:147], v[88:91], v[148:163]
    s_waitcnt lgkmcnt(0)
    v_mfma_f32_32x32x16_bf16 v[148:163], v[144:147], v[92:95], v[148:163]
    ds_write_b32 v5, v6 offset:264
    ds_read_b64 v[4:5], v4
    s_waitcnt lgkmcnt(0)
    s_lshl_b32 s51, s49, 3
    s_and_b32 s52, s88, 1
    s_lshl_b32 s52, s52, 2
    s_add_u32 s51, s51, s52
    s_lshr_b32 s52, s88, 1
    s_add_u32 s51, s51, s52
    s_lshl_b32 s51, s51, 3
    s_add_u32 s51, s51, s50
    s_lshl_b32 s52, s51, 10
    s_add_u32 s52, s52, 8388608
    v_cvt_f32_f64 v4, v[4:5]
    v_rcp_f32 v4, v4
    s_nop 0
    v_pk_mul_f32 v[148:149], v[148:149], v[4:5] op_sel_hi:[1,0]
    v_pk_mul_f32 v[150:151], v[150:151], v[4:5] op_sel_hi:[1,0]
    v_pk_mul_f32 v[152:153], v[152:153], v[4:5] op_sel_hi:[1,0]
    v_pk_mul_f32 v[154:155], v[154:155], v[4:5] op_sel_hi:[1,0]
    v_cvt_pk_bf16_f32 v148, v148, v149
    v_cvt_pk_bf16_f32 v149, v150, v151
    v_cvt_pk_bf16_f32 v150, v152, v153
    v_cvt_pk_bf16_f32 v151, v154, v155
    v_min_u32 v148, -2, v148
    v_min_u32 v149, -2, v149
    v_min_u32 v150, -2, v150
    v_min_u32 v151, -2, v151
    s_cmp_lt_u32 s88, 6
    s_cbranch_scc1 L_nf_108
    s_add_u32 s51, s52, 2097152
    buffer_store_dwordx4 v[148:151], v2, s[32:35], s51 offen
L_nf_108:
    buffer_store_dwordx4 v[148:151], v2, s[32:35], s52 offen sc1
    s_add_u32 s88, s88, 4
    s_setpc_b64 s[94:95]
L_slow:
    s_setprio 0
    s_lshl_b32 s51, s48, 9
    s_add_u32 s51, s51, 149504
    v_lshl_add_u32 v5, v1, 3, s51
    v_mov_b32 v10, 0
    v_mov_b32 v11, 0
    s_waitcnt lgkmcnt(0)
    v_mov_b32 v3, 1
    s_mov_b64 exec, 1
    ds_add_u32 v6, v3 offset:56
    s_mov_b64 exec, -1
    s_mov_b32 s3, 2097152
L_lw_109:
    ds_read_b32 v3, v6 offset:56
    s_sub_u32 s3, s3, 1
    s_waitcnt lgkmcnt(0)
    v_cmp_gt_u32 vcc, 8, v3
    s_cbranch_vccz L_lwd_110
    s_sleep 1
    s_cbranch_scc0 L_lw_109
L_lwd_110:
    ds_write_b64 v5, v[10:11]
    ds_write_b32 v6, v10 offset:92
    s_waitcnt lgkmcnt(0)
    v_lshlrev_b32 v7, 3, v1
    v_add_u32 v7, 147456, v7
    v_mov_b32 v10, 0
    v_mov_b32 v11, 0x3ff00000
    s_mov_b32 s85, 1075576832
    s_mov_b32 s84, 0
    s_mov_b32 s88, 0
    v_and_b32 v0, 31, v1
    v_lshlrev_b32 v0, 2, v0
    v_add_u32 v0, 162048, v0
    s_lshl_b32 s51, s48, 7
    v_add_u32 v4, s51, v0
    v_mov_b32 v3, 0xff800000
    ds_write_b32 v4, v3
    s_waitcnt lgkmcnt(0)
    v_mov_b32 v3, 1
    s_mov_b64 exec, 1
    ds_add_u32 v6, v3 offset:32
    s_mov_b64 exec, -1
    s_mov_b32 s3, 2097152
L_lw_111:
    ds_read_b32 v3, v6 offset:32
    s_sub_u32 s3, s3, 1
    s_waitcnt lgkmcnt(0)
    v_cmp_gt_u32 vcc, 8, v3
    s_cbranch_vccz L_lwd_112
    s_sleep 1
    s_cbranch_scc0 L_lw_111
L_lwd_112:
    v_add_u32 v8, 153600, v2
    v_mov_b32 v5, v0
    s_mov_b32 s55, 8
L_sp1_113:
    ds_read_b128 v[12:15], v8
    v_mov_b32 v3, 0xff800000
    s_waitcnt lgkmcnt(0)
    v_mfma_f32_32x32x16_bf16 v[112:127], v[16:19], v[12:15], 0
    s_nop 11
    v_max3_f32 v3, v112, v113, v3
    v_max3_f32 v3, v114, v115, v3
    v_max3_f32 v3, v116, v117, v3
    v_max3_f32 v3, v118, v119, v3
    v_max3_f32 v3, v120, v121, v3
    v_max3_f32 v3, v122, v123, v3
    v_max3_f32 v3, v124, v125, v3
    v_max3_f32 v3, v126, v127, v3
    v_mfma_f32_32x32x16_bf16 v[112:127], v[20:23], v[12:15], 0
    s_nop 11
    v_max3_f32 v3, v112, v113, v3
    v_max3_f32 v3, v114, v115, v3
    v_max3_f32 v3, v116, v117, v3
    v_max3_f32 v3, v118, v119, v3
    v_max3_f32 v3, v120, v121, v3
    v_max3_f32 v3, v122, v123, v3
    v_max3_f32 v3, v124, v125, v3
    v_max3_f32 v3, v126, v127, v3
    v_mfma_f32_32x32x16_bf16 v[112:127], v[24:27], v[12:15], 0
    s_nop 11
    v_max3_f32 v3, v112, v113, v3
    v_max3_f32 v3, v114, v115, v3
    v_max3_f32 v3, v116, v117, v3
    v_max3_f32 v3, v118, v119, v3
    v_max3_f32 v3, v120, v121, v3
    v_max3_f32 v3, v122, v123, v3
    v_max3_f32 v3, v124, v125, v3
    v_max3_f32 v3, v126, v127, v3
    v_mfma_f32_32x32x16_bf16 v[112:127], v[28:31], v[12:15], 0
    s_nop 11
    v_max3_f32 v3, v112, v113, v3
    v_max3_f32 v3, v114, v115, v3
    v_max3_f32 v3, v116, v117, v3
    v_max3_f32 v3, v118, v119, v3
    v_max3_f32 v3, v120, v121, v3
    v_max3_f32 v3, v122, v123, v3
    v_max3_f32 v3, v124, v125, v3
    v_max3_f32 v3, v126, v127, v3
    v_mfma_f32_32x32x16_bf16 v[112:127], v[32:35], v[12:15], 0
    s_nop 11
    v_max3_f32 v3, v112, v113, v3
    v_max3_f32 v3, v114, v115, v3
    v_max3_f32 v3, v116, v117, v3
    v_max3_f32 v3, v118, v119, v3
    v_max3_f32 v3, v120, v121, v3
    v_max3_f32 v3, v122, v123, v3
    v_max3_f32 v3, v124, v125, v3
    v_max3_f32 v3, v126, v127, v3
    v_mfma_f32_32x32x16_bf16 v[112:127], v[36:39], v[12:15], 0
    s_nop 11
    v_max3_f32 v3, v112, v113, v3
    v_max3_f32 v3, v114, v115, v3
    v_max3_f32 v3, v116, v117, v3
    v_max3_f32 v3, v118, v119, v3
    v_max3_f32 v3, v120, v121, v3
    v_max3_f32 v3, v122, v123, v3
    v_max3_f32 v3, v124, v125, v3
    v_max3_f32 v3, v126, v127, v3
    v_mfma_f32_32x32x16_bf16 v[112:127], v[40:43], v[12:15], 0
    s_nop 11
    v_max3_f32 v3, v112, v113, v3
    v_max3_f32 v3, v114, v115, v3
    v_max3_f32 v3, v116, v117, v3
    v_max3_f32 v3, v118, v119, v3
    v_max3_f32 v3, v120, v121, v3
    v_max3_f32 v3, v122, v123, v3
    v_max3_f32 v3, v124, v125, v3
    v_max3_f32 v3, v126, v127, v3
    v_mfma_f32_32x32x16_bf16 v[112:127], v[44:47], v[12:15], 0
    s_nop 11
    v_max3_f32 v3, v112, v113, v3
    v_max3_f32 v3, v114, v115, v3
    v_max3_f32 v3, v116, v117, v3
    v_max3_f32 v3, v118, v119, v3
    v_max3_f32 v3, v120, v121, v3
    v_max3_f32 v3, v122, v123, v3
    v_max3_f32 v3, v124, v125, v3
    v_max3_f32 v3, v126, v127, v3
    ds_max_f32 v5, v3
    v_add_u32 v8, 1024, v8
    v_add_u32 v5, 128, v5
    s_sub_u32 s55, s55, 1
    s_cmp_lg_u32 s55, 0
    s_cbranch_scc1 L_sp1_113
    s_waitcnt lgkmcnt(0)
    v_mov_b32 v3, 1
    s_mov_b64 exec, 1
    ds_add_u32 v6, v3 offset:36
    s_mov_b64 exec, -1
    s_mov_b32 s3, 2097152
L_lw_114:
    ds_read_b32 v3, v6 offset:36
    s_sub_u32 s3, s3, 1
    s_waitcnt lgkmcnt(0)
    v_cmp_gt_u32 vcc, 8, v3
    s_cbranch_vccz L_lwd_115
    s_sleep 1
    s_cbranch_scc0 L_lw_114
L_lwd_115:
    v_add_u32 v8, 153600, v2
    s_mov_b32 s55, 8
L_sp2_116:
    ds_read_b128 v[12:15], v8
    ds_read_b32 v3, v0
    s_waitcnt lgkmcnt(0)
    v_sub_f32 v128, 0, v3
    v_sub_f32 v129, 0, v3
    v_sub_f32 v130, 0, v3
    v_sub_f32 v131, 0, v3
    v_sub_f32 v132, 0, v3
    v_sub_f32 v133, 0, v3
    v_sub_f32 v134, 0, v3
    v_sub_f32 v135, 0, v3
    v_sub_f32 v136, 0, v3
    v_sub_f32 v137, 0, v3
    v_sub_f32 v138, 0, v3
    v_sub_f32 v139, 0, v3
    v_sub_f32 v140, 0, v3
    v_sub_f32 v141, 0, v3
    v_sub_f32 v142, 0, v3
    v_sub_f32 v143, 0, v3
    s_nop 1
    v_mfma_f32_32x32x16_bf16 v[112:127], v[16:19], v[12:15], v[128:143]
    s_nop 11
    v_exp_f32 v112, v112
    v_exp_f32 v113, v113
    v_exp_f32 v114, v114
    v_exp_f32 v115, v115
    v_exp_f32 v116, v116
    v_exp_f32 v117, v117
    v_exp_f32 v118, v118
    v_exp_f32 v119, v119
    v_exp_f32 v120, v120
    v_exp_f32 v121, v121
    v_exp_f32 v122, v122
    v_exp_f32 v123, v123
    v_exp_f32 v124, v124
    v_exp_f32 v125, v125
    v_exp_f32 v126, v126
    v_exp_f32 v127, v127
    v_cvt_pk_bf16_f32 v112, v112, v113
    v_cvt_pk_bf16_f32 v113, v114, v115
    v_cvt_pk_bf16_f32 v114, v116, v117
    v_cvt_pk_bf16_f32 v115, v118, v119
    v_cvt_pk_bf16_f32 v116, v120, v121
    v_cvt_pk_bf16_f32 v117, v122, v123
    v_cvt_pk_bf16_f32 v118, v124, v125
    v_cvt_pk_bf16_f32 v119, v126, v127
    s_nop 1
    v_mfma_f32_32x32x16_bf16 v[144:159], v[48:51], v[112:115], 0
    v_mfma_f32_32x32x16_bf16 v[144:159], v[52:55], v[116:119], v[144:159]
    v_mfma_f32_32x32x16_bf16 v[112:127], v[20:23], v[12:15], v[128:143]
    s_nop 11
    v_exp_f32 v112, v112
    v_exp_f32 v113, v113
    v_exp_f32 v114, v114
    v_exp_f32 v115, v115
    v_exp_f32 v116, v116
    v_exp_f32 v117, v117
    v_exp_f32 v118, v118
    v_exp_f32 v119, v119
    v_exp_f32 v120, v120
    v_exp_f32 v121, v121
    v_exp_f32 v122, v122
    v_exp_f32 v123, v123
    v_exp_f32 v124, v124
    v_exp_f32 v125, v125
    v_exp_f32 v126, v126
    v_exp_f32 v127, v127
    v_cvt_pk_bf16_f32 v112, v112, v113
    v_cvt_pk_bf16_f32 v113, v114, v115
    v_cvt_pk_bf16_f32 v114, v116, v117
    v_cvt_pk_bf16_f32 v115, v118, v119
    v_cvt_pk_bf16_f32 v116, v120, v121
    v_cvt_pk_bf16_f32 v117, v122, v123
    v_cvt_pk_bf16_f32 v118, v124, v125
    v_cvt_pk_bf16_f32 v119, v126, v127
    s_nop 1
    v_mfma_f32_32x32x16_bf16 v[144:159], v[56:59], v[112:115], v[144:159]
    v_mfma_f32_32x32x16_bf16 v[144:159], v[60:63], v[116:119], v[144:159]
    v_mfma_f32_32x32x16_bf16 v[112:127], v[24:27], v[12:15], v[128:143]
    s_nop 11
    v_exp_f32 v112, v112
    v_exp_f32 v113, v113
    v_exp_f32 v114, v114
    v_exp_f32 v115, v115
    v_exp_f32 v116, v116
    v_exp_f32 v117, v117
    v_exp_f32 v118, v118
    v_exp_f32 v119, v119
    v_exp_f32 v120, v120
    v_exp_f32 v121, v121
    v_exp_f32 v122, v122
    v_exp_f32 v123, v123
    v_exp_f32 v124, v124
    v_exp_f32 v125, v125
    v_exp_f32 v126, v126
    v_exp_f32 v127, v127
    v_cvt_pk_bf16_f32 v112, v112, v113
    v_cvt_pk_bf16_f32 v113, v114, v115
    v_cvt_pk_bf16_f32 v114, v116, v117
    v_cvt_pk_bf16_f32 v115, v118, v119
    v_cvt_pk_bf16_f32 v116, v120, v121
    v_cvt_pk_bf16_f32 v117, v122, v123
    v_cvt_pk_bf16_f32 v118, v124, v125
    v_cvt_pk_bf16_f32 v119, v126, v127
    s_nop 1
    v_mfma_f32_32x32x16_bf16 v[144:159], v[64:67], v[112:115], v[144:159]
    v_mfma_f32_32x32x16_bf16 v[144:159], v[68:71], v[116:119], v[144:159]
    v_mfma_f32_32x32x16_bf16 v[112:127], v[28:31], v[12:15], v[128:143]
    s_nop 11
    v_exp_f32 v112, v112
    v_exp_f32 v113, v113
    v_exp_f32 v114, v114
    v_exp_f32 v115, v115
    v_exp_f32 v116, v116
    v_exp_f32 v117, v117
    v_exp_f32 v118, v118
    v_exp_f32 v119, v119
    v_exp_f32 v120, v120
    v_exp_f32 v121, v121
    v_exp_f32 v122, v122
    v_exp_f32 v123, v123
    v_exp_f32 v124, v124
    v_exp_f32 v125, v125
    v_exp_f32 v126, v126
    v_exp_f32 v127, v127
    v_cvt_pk_bf16_f32 v112, v112, v113
    v_cvt_pk_bf16_f32 v113, v114, v115
    v_cvt_pk_bf16_f32 v114, v116, v117
    v_cvt_pk_bf16_f32 v115, v118, v119
    v_cvt_pk_bf16_f32 v116, v120, v121
    v_cvt_pk_bf16_f32 v117, v122, v123
    v_cvt_pk_bf16_f32 v118, v124, v125
    v_cvt_pk_bf16_f32 v119, v126, v127
    s_nop 1
    v_mfma_f32_32x32x16_bf16 v[144:159], v[72:75], v[112:115], v[144:159]
    v_mfma_f32_32x32x16_bf16 v[144:159], v[76:79], v[116:119], v[144:159]
    v_mfma_f32_32x32x16_bf16 v[112:127], v[32:35], v[12:15], v[128:143]
    s_nop 11
    v_exp_f32 v112, v112
    v_exp_f32 v113, v113
    v_exp_f32 v114, v114
    v_exp_f32 v115, v115
    v_exp_f32 v116, v116
    v_exp_f32 v117, v117
    v_exp_f32 v118, v118
    v_exp_f32 v119, v119
    v_exp_f32 v120, v120
    v_exp_f32 v121, v121
    v_exp_f32 v122, v122
    v_exp_f32 v123, v123
    v_exp_f32 v124, v124
    v_exp_f32 v125, v125
    v_exp_f32 v126, v126
    v_exp_f32 v127, v127
    v_cvt_pk_bf16_f32 v112, v112, v113
    v_cvt_pk_bf16_f32 v113, v114, v115
    v_cvt_pk_bf16_f32 v114, v116, v117
    v_cvt_pk_bf16_f32 v115, v118, v119
    v_cvt_pk_bf16_f32 v116, v120, v121
    v_cvt_pk_bf16_f32 v117, v122, v123
    v_cvt_pk_bf16_f32 v118, v124, v125
    v_cvt_pk_bf16_f32 v119, v126, v127
    s_nop 1
    v_mfma_f32_32x32x16_bf16 v[144:159], v[80:83], v[112:115], v[144:159]
    v_mfma_f32_32x32x16_bf16 v[144:159], v[84:87], v[116:119], v[144:159]
    v_mfma_f32_32x32x16_bf16 v[112:127], v[36:39], v[12:15], v[128:143]
    s_nop 11
    v_exp_f32 v112, v112
    v_exp_f32 v113, v113
    v_exp_f32 v114, v114
    v_exp_f32 v115, v115
    v_exp_f32 v116, v116
    v_exp_f32 v117, v117
    v_exp_f32 v118, v118
    v_exp_f32 v119, v119
    v_exp_f32 v120, v120
    v_exp_f32 v121, v121
    v_exp_f32 v122, v122
    v_exp_f32 v123, v123
    v_exp_f32 v124, v124
    v_exp_f32 v125, v125
    v_exp_f32 v126, v126
    v_exp_f32 v127, v127
    v_cvt_pk_bf16_f32 v112, v112, v113
    v_cvt_pk_bf16_f32 v113, v114, v115
    v_cvt_pk_bf16_f32 v114, v116, v117
    v_cvt_pk_bf16_f32 v115, v118, v119
    v_cvt_pk_bf16_f32 v116, v120, v121
    v_cvt_pk_bf16_f32 v117, v122, v123
    v_cvt_pk_bf16_f32 v118, v124, v125
    v_cvt_pk_bf16_f32 v119, v126, v127
    s_nop 1
    v_mfma_f32_32x32x16_bf16 v[144:159], v[88:91], v[112:115], v[144:159]
    v_mfma_f32_32x32x16_bf16 v[144:159], v[92:95], v[116:119], v[144:159]
    v_mfma_f32_32x32x16_bf16 v[112:127], v[40:43], v[12:15], v[128:143]
    s_nop 11
    v_exp_f32 v112, v112
    v_exp_f32 v113, v113
    v_exp_f32 v114, v114
    v_exp_f32 v115, v115
    v_exp_f32 v116, v116
    v_exp_f32 v117, v117
    v_exp_f32 v118, v118
    v_exp_f32 v119, v119
    v_exp_f32 v120, v120
    v_exp_f32 v121, v121
    v_exp_f32 v122, v122
    v_exp_f32 v123, v123
    v_exp_f32 v124, v124
    v_exp_f32 v125, v125
    v_exp_f32 v126, v126
    v_exp_f32 v127, v127
    v_cvt_pk_bf16_f32 v112, v112, v113
    v_cvt_pk_bf16_f32 v113, v114, v115
    v_cvt_pk_bf16_f32 v114, v116, v117
    v_cvt_pk_bf16_f32 v115, v118, v119
    v_cvt_pk_bf16_f32 v116, v120, v121
    v_cvt_pk_bf16_f32 v117, v122, v123
    v_cvt_pk_bf16_f32 v118, v124, v125
    v_cvt_pk_bf16_f32 v119, v126, v127
    s_nop 1
    v_mfma_f32_32x32x16_bf16 v[144:159], v[96:99], v[112:115], v[144:159]
    v_mfma_f32_32x32x16_bf16 v[144:159], v[100:103], v[116:119], v[144:159]
    v_mfma_f32_32x32x16_bf16 v[112:127], v[44:47], v[12:15], v[128:143]
    s_nop 11
    v_exp_f32 v112, v112
    v_exp_f32 v113, v113
    v_exp_f32 v114, v114
    v_exp_f32 v115, v115
    v_exp_f32 v116, v116
    v_exp_f32 v117, v117
    v_exp_f32 v118, v118
    v_exp_f32 v119, v119
    v_exp_f32 v120, v120
    v_exp_f32 v121, v121
    v_exp_f32 v122, v122
    v_exp_f32 v123, v123
    v_exp_f32 v124, v124
    v_exp_f32 v125, v125
    v_exp_f32 v126, v126
    v_exp_f32 v127, v127
    v_cvt_pk_bf16_f32 v112, v112, v113
    v_cvt_pk_bf16_f32 v113, v114, v115
    v_cvt_pk_bf16_f32 v114, v116, v117
    v_cvt_pk_bf16_f32 v115, v118, v119
    v_cvt_pk_bf16_f32 v116, v120, v121
    v_cvt_pk_bf16_f32 v117, v122, v123
    v_cvt_pk_bf16_f32 v118, v124, v125
    v_cvt_pk_bf16_f32 v119, v126, v127
    s_nop 1
    v_mfma_f32_32x32x16_bf16 v[144:159], v[104:107], v[112:115], v[144:159]
    v_mfma_f32_32x32x16_bf16 v[144:159], v[108:111], v[116:119], v[144:159]
    s_nop 11
    ds_read_b32 v3, v7 offset:264
    v_cvt_pk_bf16_f32 v156, v144, v145
    v_cvt_pk_bf16_f32 v157, v146, v147
    v_cvt_pk_bf16_f32 v158, v148, v149
    v_cvt_pk_bf16_f32 v159, v150, v151
    v_add_u32 v4, s88, v9
    s_waitcnt lgkmcnt(0)
    v_readfirstlane_b32 s51, v3
    s_nop 0
    s_cmp_lt_u32 s84, 4
    s_cselect_b32 s51, 1, s51
    s_cmp_lg_u32 s51, 0
    s_cbranch_scc1 L_sf_117
    s_call_b64 s[86:87], L_wslot
L_sf_117:
    ds_write_b128 v4, v[156:159]
    s_mov_b32 exec_hi, 0
    v_cvt_f64_f32 v[10:11], v152
    s_mov_b32 exec_hi, 1
    ds_add_rtn_f64 v[4:5], v7, v[10:11] offset:2048
    s_mov_b32 exec_hi, -1
    v_add_u32 v3, 141312, v2
    v_and_b32 v12, 31, v1
    v_lshlrev_b32 v12, 3, v12
    v_add_u32 v12, 153088, v12
    ds_read_b64 v[12:13], v12
    ds_read_b128 v[112:115], v3 offset:0
    ds_read_b128 v[116:119], v3 offset:1024
    ds_read_b128 v[120:123], v3 offset:2048
    ds_read_b128 v[124:127], v3 offset:3072
    ds_read_b128 v[128:131], v3 offset:4096
    ds_read_b128 v[132:135], v3 offset:5120
    ds_read_b128 v[136:139], v3 offset:6144
    ds_read_b128 v[140:143], v3 offset:7168
    v_add_u32 v7, 512, v7
    s_add_u32 s88, s88, 8192
    s_and_b32 s88, s88, 0x6000
    s_waitcnt lgkmcnt(9)
    v_readlane_b32 s51, v5, 32
    s_nop 0
    s_cmp_lg_u32 s51, s85
    s_cbranch_scc1 L_nl_118
    s_cmp_lg_u32 s84, 7
    s_cbranch_scc1 L_nl_118
    s_call_b64 s[86:87], L_pub
L_nl_118:
    s_waitcnt lgkmcnt(0)
    s_add_u32 s84, s84, 1
    v_add_u32 v8, 1024, v8
    v_add_u32 v0, 128, v0
    s_sub_u32 s55, s55, 1
    s_cmp_lg_u32 s55, 0
    s_cbranch_scc1 L_sp2_116
    s_branch L_aend
L_end:
    s_endpgm
L_code_end:
.section .rodata,"a"
.p2align 6
.amdhsa_kernel recurrent_scan__grouped_kv_mqa__dense_activation_relu__prompt_kernel
  .amdhsa_next_free_vgpr 168
  .amdhsa_next_free_sgpr 100
  .amdhsa_accum_offset 168
  .amdhsa_group_segment_fixed_size 0
  .amdhsa_kernarg_size 88
  .amdhsa_user_sgpr_count 2
  .amdhsa_user_sgpr_kernarg_segment_ptr 1
  .amdhsa_system_sgpr_workgroup_id_x 1
  .amdhsa_float_denorm_mode_32 3
  .amdhsa_float_denorm_mode_16_64 3
.end_amdhsa_kernel
```
